```python
import torch

def _softmax(x, axis=-1):
    return torch.softmax(x, dim=axis)
def _gelu(x):
    return torch.nn.functional.gelu(x, approximate="tanh")
def _silu(x):
    return torch.nn.functional.silu(x)
def _sigmoid(x):
    return torch.sigmoid(x)
def _layernorm(x, axis=-1, eps=1e-5):
    m = x.mean(dim=axis, keepdim=True)
    v = x.var(dim=axis, keepdim=True, unbiased=False)
    return (x - m) / torch.sqrt(v + eps)
def _scatter_add(tgt, idx, src, axis=0):
    return tgt.clone().index_add_(axis, idx, src)
def _segment_sum(src, seg, n):
    out = torch.zeros((n,) + src.shape[1:], dtype=src.dtype)
    return out.index_add_(0, seg, src)
def _pad(x, pw):
    flat = tuple(v for pair in reversed(pw) for v in pair)
    return torch.nn.functional.pad(x, flat)

kernel_name = 'concat_heads__gqa_block_cached__mha_block_cached__near_ridge'

def setup_inputs():

    _w = (lambda a: (lambda t: t.to(torch.bfloat16) if t.is_floating_point() else t)(torch.as_tensor(a)))
    def _A_setup():
        B, Sq, D = 16, 48, 576
        Hq, Hkv, Sk, Dh = 32, 16, 48, 128
        assert Hq % Hkv == 0, (Hq, Hkv)
        return {
            "x": _w((lambda *s: torch.randn(*s, dtype=torch.bfloat16) * 0.8)(B, Sq, D)),
            "k_cache": _w((lambda *s: torch.randn(*s, dtype=torch.bfloat16) * 0.8)(B, Hkv, Sk, Dh)),
            "v_cache": _w((lambda *s: torch.randn(*s, dtype=torch.bfloat16) * 0.05)(B, Hkv, Sk, Dh)),
            "wq": _w((lambda *s: torch.randn(*s, dtype=torch.bfloat16) * 0.8)(D, Hq * Dh) * (D ** -0.5)),
            "wo": _w((lambda *s: torch.randn(*s, dtype=torch.bfloat16) * 0.05)(Hq * Dh, D) * ((Hq * Dh) ** -0.5)),
        }
    _A_in = _A_setup()

    def _B_setup():
        B, Sq, D = 16, 48, 576
        H, Sk, Dh = 32, 48, 128
        return {
            "x": _w((lambda *s: torch.randn(*s, dtype=torch.bfloat16) * 0.8)(B, Sq, D)),
            "k_cache": _w((lambda *s: torch.randn(*s, dtype=torch.bfloat16) * 0.8)(B, H, Sk, Dh)),
            "v_cache": _w((lambda *s: torch.randn(*s, dtype=torch.bfloat16) * 0.05)(B, H, Sk, Dh)),
            "wq": _w((lambda *s: torch.randn(*s, dtype=torch.bfloat16) * 0.8)(D, H * Dh) * (D ** -0.5)),
            "wo": _w((lambda *s: torch.randn(*s, dtype=torch.bfloat16) * 0.05)(H * Dh, D) * ((H * Dh) ** -0.5)),
        }
    _B_in = _B_setup()

    return {
        "A_x": _A_in["x"],
        "A_k_cache": _A_in["k_cache"],
        "A_v_cache": _A_in["v_cache"],
        "A_wq": _A_in["wq"],
        "A_wo": _A_in["wo"],
        "B_x": _B_in["x"],
        "B_k_cache": _B_in["k_cache"],
        "B_v_cache": _B_in["v_cache"],
        "B_wq": _B_in["wq"],
        "B_wo": _B_in["wo"],
    }

def reference(A_x, A_k_cache, A_v_cache, A_wq, A_wo, B_x, B_k_cache, B_v_cache, B_wq, B_wo):
    def _A_ref(x, k_cache, v_cache, wq, wo):
        B, Sq, D = x.shape
        Hq, Dh = 32, 128
        Hkv = k_cache.shape[1]
        rep = Hq // Hkv
        q = (lambda x, *d: x.permute(*d))((x @ wq).reshape(B, Sq, Hq, Dh), 0, 2, 1, 3)
        k = (lambda x, n, axis: torch.repeat_interleave(x, n, dim=axis))(k_cache, rep, axis=1)
        v = (lambda x, n, axis: torch.repeat_interleave(x, n, dim=axis))(v_cache, rep, axis=1)
        scores = torch.einsum("bhqd,bhkd->bhqk", q, k) * (Dh ** -0.5)
        p = _softmax(scores, axis=-1)
        o = torch.einsum("bhqk,bhkd->bhqd", p, v)
        return (lambda x, *d: x.permute(*d))(o, 0, 2, 1, 3).reshape(B, Sq, Hq * Dh) @ wo

    def _B_ref(x, k_cache, v_cache, wq, wo):
        B, Sq, D = x.shape
        H, Dh = 32, 128
        q = (lambda x, *d: x.permute(*d))((x @ wq).reshape(B, Sq, H, Dh), 0, 2, 1, 3)
        scores = torch.einsum("bhqd,bhkd->bhqk", q, k_cache) * (Dh ** -0.5)
        p = _softmax(scores, axis=-1)
        o = torch.einsum("bhqk,bhkd->bhqd", p, v_cache)
        return (lambda x, *d: x.permute(*d))(o, 0, 2, 1, 3).reshape(B, Sq, H * Dh) @ wo

    a = _A_ref(A_x, A_k_cache, A_v_cache, A_wq, A_wo)
    b = _B_ref(B_x, B_k_cache, B_v_cache, B_wq, B_wo)
    return torch.concatenate([a, b], axis=-1)
```

```asm
; @launch grid=(256,1,1) block=(512,1,1) lds=163840
.amdgcn_target "amdgcn-amd-amdhsa--gfx950"
.text
.globl concat_heads__gqa_block_cached__mha_block_cached__near_ridge_kernel
.p2align 8
.type concat_heads__gqa_block_cached__mha_block_cached__near_ridge_kernel,@function
concat_heads__gqa_block_cached__mha_block_cached__near_ridge_kernel:
KSTART:
    s_cmp_ge_u32 s2, 256
    s_cbranch_scc1 M_END
    s_load_dwordx8 s[24:31], s[0:1], 0
    s_load_dwordx8 s[32:39], s[0:1], 40
    s_load_dwordx2 s[40:41], s[0:1], 96
    s_load_dwordx2 s[20:21], s[0:1], 32
    s_load_dwordx2 s[22:23], s[0:1], 72
    s_load_dwordx4 s[52:55], s[0:1], 80
    v_lshrrev_b32 v4, 6, v0
    s_getpc_b64 s[16:17]
PCREF:
    v_readfirstlane_b32 s45, v4
    s_nop 0
    s_cmp_lt_u32 s45, 4
    s_cbranch_scc1 NOCPF
    s_lshr_b32 s18, s2, 3
    s_lshl_b32 s18, s18, 2
    s_add_u32 s18, s18, s45
    s_mul_i32 s18, s18, 256
    s_sub_u32 s18, s18, 1024
    s_min_u32 s18, s18, CODE_END - PCREF - 196
    s_add_u32 s16, s16, s18
    s_addc_u32 s17, s17, 0
    s_load_dword s96, s[16:17], 0
    s_load_dword s97, s[16:17], 64
    s_load_dword s98, s[16:17], 128
    s_load_dword s99, s[16:17], 192
NOCPF:
    s_and_b32 s47, s2, 7
    s_lshr_b32 s48, s2, 3
    s_lshr_b32 s42, s47, 2
    s_and_b32 s49, s47, 3
    s_lshl_b32 s49, s49, 2
    s_and_b32 s3, s48, 3
    s_add_u32 s43, s49, s3
    s_lshr_b32 s44, s48, 2
    s_and_b32 s49, s43, 1
    s_lshl_b32 s62, s44, 1
    s_add_u32 s62, s62, s49
    s_lshl_b32 s63, s42, 3
    s_add_u32 s63, s63, s44
    s_lshl_b32 s63, s63, 4
    s_add_u32 s63, s63, s43
    v_lshrrev_b32 v4, 6, v0
    v_and_b32 v1, 63, v0
    v_and_b32 v2, 15, v0
    v_lshrrev_b32 v3, 4, v1
    v_readfirstlane_b32 s45, v4
    s_nop 0
    s_and_b32 s46, s45, 3
    s_xor_b32 s45, s45, 4
    s_cmp_lt_u32 s45, 4
    s_cbranch_scc1 COMPUTE
HELPER:
    s_lshl_b32 s47, s3, 1
    s_add_u32 s47, s47, s44
    s_cmp_ge_u32 s47, 9
    s_cselect_b32 s48, 9, 0
    s_sub_u32 s47, s47, s48
    s_mov_b32 s60, s47
    s_and_b32 s48, s46, 1
    s_lshl_b32 s48, s48, 17
    s_lshl_b32 s49, s43, 1
    s_lshr_b32 s50, s46, 1
    s_add_u32 s49, s49, s50
    s_lshl_b32 s49, s49, 8
    s_add_u32 s48, s48, s49
    v_lshlrev_b32 v4, 13, v3
    v_add_u32 v4, s48, v4
    v_lshlrev_b32 v5, 1, v3
    v_xor_b32 v5, v5, v2
    v_lshlrev_b32 v5, 4, v5
    v_xor_b32 v6, 128, v5
    v_add_u32 v5, v4, v5
    v_add_u32 v6, v4, v6
    v_add_u32 v8, 0, v5
    v_add_u32 v9, 31744, v5
    v_add_u32 v10, 63488, v6
    v_add_u32 v11, 95232, v6
    s_mul_i32 s48, s44, 96
    s_mul_i32 s49, s46, 24
    s_add_u32 s48, s48, s49
    s_mul_i32 s48, s48, 1152
    v_lshrrev_b32 v4, 3, v1
    v_mul_u32_u24 v4, 1152, v4
    v_add_u32 v7, s48, v4
    v_and_b32 v5, 7, v1
    v_xor_b32 v5, v5, v3
    s_and_b32 s49, s46, 1
    s_lshl_b32 s49, s49, 2
    v_xor_b32 v5, s49, v5
    v_lshlrev_b32 v5, 4, v5
    v_xor_b32 v6, 64, v5
    v_add_u32 v5, v7, v5
    v_add_u32 v6, v7, v6
    v_add_u32 v12, 0, v5
    v_add_u32 v13, 8192, v6
    v_add_u32 v14, 16384, v5
    s_lshl_b32 s56, s46, 12
    s_lshl_b32 s57, s46, 13
    s_mul_i32 s58, s46, 3072
    s_waitcnt lgkmcnt(0)
    s_cmp_eq_u32 s42, 0
    s_cselect_b64 s[24:25], s[24:25], s[32:33]
    s_cselect_b64 s[26:27], s[26:27], s[34:35]
    s_cselect_b64 s[28:29], s[28:29], s[36:37]
    s_cselect_b64 s[30:31], s[30:31], s[38:39]
    s_cselect_b64 s[32:33], s[20:21], s[22:23]
    s_mov_b32 s59, 6291456
    s_cselect_b32 s59, 3145728, s59
    s_mov_b32 s4, s24
    s_and_b32 s5, s25, 0xffff
    s_mov_b32 s6, 0xd8000
    s_mov_b32 s7, 0x20000
    s_mov_b32 s8, s30
    s_and_b32 s9, s31, 0xffff
    s_mov_b32 s10, 0x480000
    s_mov_b32 s11, 0x20000
    s_lshl_b32 s48, s60, 7
    s_add_u32 m0, s58, 49152
    s_nop 0
    buffer_load_dwordx4 v12, s[4:7], s48 offen offset:0 lds
    buffer_load_dwordx4 v13, s[4:7], s48 offen offset:1024 lds
    buffer_load_dwordx4 v14, s[4:7], s48 offen offset:2048 lds
    s_add_u32 s60, s60, 1
    s_cmp_eq_u32 s60, 9
    s_cselect_b32 s60, 0, s60
    s_lshl_b32 s49, s47, 19
    s_add_u32 m0, s56, 98304
    s_nop 0
    buffer_load_dwordx4 v8, s[8:11], s49 offen offset:0 lds
    buffer_load_dwordx4 v9, s[8:11], s49 offen offset:1024 lds
    buffer_load_dwordx4 v10, s[8:11], s49 offen offset:2048 lds
    buffer_load_dwordx4 v11, s[8:11], s49 offen offset:3072 lds
    s_lshl_b32 s49, s47, 19
    s_add_u32 s49, s49, 262144
    s_add_u32 m0, s56, 114688
    s_nop 0
    buffer_load_dwordx4 v8, s[8:11], s49 offen offset:0 lds
    buffer_load_dwordx4 v9, s[8:11], s49 offen offset:1024 lds
    buffer_load_dwordx4 v10, s[8:11], s49 offen offset:2048 lds
    buffer_load_dwordx4 v11, s[8:11], s49 offen offset:3072 lds
    s_add_u32 s47, s47, 1
    s_cmp_eq_u32 s47, 9
    s_cselect_b32 s47, 0, s47
    s_mov_b32 s12, s26
    s_and_b32 s13, s27, 0xffff
    s_mov_b32 s14, s59
    s_mov_b32 s15, 0x20000
    s_mov_b32 s16, s28
    s_and_b32 s17, s29, 0xffff
    s_mov_b32 s18, s59
    s_mov_b32 s19, 0x20000
    s_mov_b32 s20, s32
    s_and_b32 s21, s33, 0xffff
    s_mov_b32 s22, 0x480000
    s_mov_b32 s23, 0x20000
    s_mov_b32 s36, s54
    s_and_b32 s37, s55, 0xffff
    s_mov_b32 s38, 0x100
    s_mov_b32 s39, 0x20000
    s_mov_b32 s28, s40
    s_and_b32 s29, s41, 0xffff
    s_mov_b32 s30, 0x126c000
    s_mov_b32 s31, 0x20000
    s_lshl_b32 s51, s44, 1
    s_lshr_b32 s50, s46, 1
    s_add_u32 s51, s51, s50
    s_lshl_b32 s50, s43, 1
    s_and_b32 s59, s46, 1
    s_add_u32 s50, s50, s59
    s_cmp_eq_u32 s42, 0
    s_cselect_b32 s59, 4, 5
    s_cselect_b32 s50, s43, s50
    s_lshl_b32 s51, s51, s59
    s_add_u32 s51, s51, s50
    s_mul_i32 s51, s51, 12288
    v_lshlrev_b32 v7, 8, v3
    v_add_u32 v7, s51, v7
    v_xor_b32 v5, v2, v3
    v_lshlrev_b32 v5, 4, v5
    v_xor_b32 v6, 0, v5
    v_add_u32 v16, v7, v6
    v_xor_b32 v6, 64, v5
    v_add_u32 v17, v7, v6
    v_xor_b32 v6, 128, v5
    v_add_u32 v18, v7, v6
    v_xor_b32 v6, 192, v5
    v_add_u32 v19, v7, v6
    v_lshlrev_b32 v5, 1, v3
    v_xor_b32 v5, v2, v5
    v_lshlrev_b32 v5, 4, v5
    v_add_u32 v20, v7, v5
    v_xor_b32 v5, 128, v5
    v_add_u32 v21, v7, v5
    v_cmp_eq_u32 vcc, 256, v0
    s_lshr_b32 s50, s63, 4
    s_lshl_b32 s50, s50, 4
    v_mov_b32 v36, s50
    v_mov_b32 v6, 0x7ffffff0
    v_cndmask_b32 v30, v6, v36, vcc
    v_mov_b32 v31, 1
    s_xor_b32 s50, s63, 1
    s_lshl_b32 s51, s50, 7
    s_add_u32 s51, s51, 19283968
    v_and_b32 v5, 1, v1
    v_lshlrev_b32 v5, 2, v5
    v_add_u32 v34, s51, v5
    s_mul_i32 s50, s50, 24576
    s_mul_i32 s51, s46, 6144
    s_add_u32 s50, s50, s51
    s_add_u32 s50, s50, 12845056
    v_lshlrev_b32 v5, 4, v1
    v_add_u32 v35, s50, v5
    s_movk_i32 s34, 4096
    s_movk_i32 s35, 8192
    s_lshl_b32 s51, s46, 6
    s_mul_i32 s51, s51, 1152
    v_add_u32 v4, s51, v4
    v_and_b32 v5, 7, v1
    v_lshlrev_b32 v6, 1, v3
    v_xor_b32 v5, v5, v6
    v_lshl_add_u32 v4, v5, 4, v4
    v_add_u32 v24, 0, v4
    v_add_u32 v25, 8192, v4
    v_add_u32 v26, 16384, v4
    v_add_u32 v27, 24576, v4
    s_lshr_b32 s61, s43, 1
    s_add_u32 s50, s44, 8
    s_cmp_ge_u32 s50, 9
    s_cselect_b32 s51, 9, 0
    s_sub_u32 s50, s50, s51
    s_lshl_b32 s84, s50, 7
    s_add_u32 s50, s61, 1
    s_and_b32 s50, s50, 7
    s_add_u32 s50, s50, s44
    s_cmp_ge_u32 s50, 9
    s_cselect_b32 s51, 9, 0
    s_sub_u32 s50, s50, s51
    s_lshl_b32 s85, s50, 7
    s_add_u32 s50, s61, 2
    s_and_b32 s50, s50, 7
    s_add_u32 s50, s50, s44
    s_cmp_ge_u32 s50, 9
    s_cselect_b32 s51, 9, 0
    s_sub_u32 s50, s50, s51
    s_lshl_b32 s86, s50, 7
    s_add_u32 s50, s61, 3
    s_and_b32 s50, s50, 7
    s_add_u32 s50, s50, s44
    s_cmp_ge_u32 s50, 9
    s_cselect_b32 s51, 9, 0
    s_sub_u32 s50, s50, s51
    s_lshl_b32 s87, s50, 7
    s_add_u32 s50, s61, 4
    s_and_b32 s50, s50, 7
    s_add_u32 s50, s50, s44
    s_cmp_ge_u32 s50, 9
    s_cselect_b32 s51, 9, 0
    s_sub_u32 s50, s50, s51
    s_lshl_b32 s88, s50, 7
    s_add_u32 s50, s61, 5
    s_and_b32 s50, s50, 7
    s_add_u32 s50, s50, s44
    s_cmp_ge_u32 s50, 9
    s_cselect_b32 s51, 9, 0
    s_sub_u32 s50, s50, s51
    s_lshl_b32 s89, s50, 7
    s_add_u32 s50, s61, 6
    s_and_b32 s50, s50, 7
    s_add_u32 s50, s50, s44
    s_cmp_ge_u32 s50, 9
    s_cselect_b32 s51, 9, 0
    s_sub_u32 s50, s50, s51
    s_lshl_b32 s90, s50, 7
    s_add_u32 s50, s61, 7
    s_and_b32 s50, s50, 7
    s_add_u32 s50, s50, s44
    s_cmp_ge_u32 s50, 9
    s_cselect_b32 s51, 9, 0
    s_sub_u32 s50, s50, s51
    s_lshl_b32 s91, s50, 7
    s_add_u32 s50, s61, 8
    s_and_b32 s50, s50, 7
    s_add_u32 s50, s50, s44
    s_cmp_ge_u32 s50, 9
    s_cselect_b32 s51, 9, 0
    s_sub_u32 s50, s50, s51
    s_lshl_b32 s92, s50, 7
    s_mul_i32 s32, s43, 294912
    s_xor_b32 s33, s43, 1
    s_mul_i32 s33, s33, 294912
    s_lshl_b32 s50, s46, 6
    s_mul_i32 s50, s50, 1152
    s_add_u32 s50, s50, s32
    s_add_u32 s50, s50, s84
    s_add_u32 s24, s20, s50
    s_addc_u32 s25, s21, 0
    s_lshl_b32 s50, s44, 2
    s_add_u32 s50, s50, s46
    s_mul_i32 s50, s50, 9216
    s_add_u32 s50, s50, s32
    s_add_u32 s26, s20, s50
    s_addc_u32 s27, s21, 0
    s_lshl_b32 s48, s60, 7
    s_add_u32 m0, s58, 61440
    s_nop 0
    buffer_load_dwordx4 v12, s[4:7], s48 offen offset:0 lds
    buffer_load_dwordx4 v13, s[4:7], s48 offen offset:1024 lds
    buffer_load_dwordx4 v14, s[4:7], s48 offen offset:2048 lds
    s_add_u32 s60, s60, 1
    s_cmp_eq_u32 s60, 9
    s_cselect_b32 s60, 0, s60
    s_lshl_b32 s49, s47, 19
    s_add_u32 m0, s56, 131072
    s_nop 0
    buffer_load_dwordx4 v8, s[8:11], s49 offen offset:0 lds
    buffer_load_dwordx4 v9, s[8:11], s49 offen offset:1024 lds
    buffer_load_dwordx4 v10, s[8:11], s49 offen offset:2048 lds
    buffer_load_dwordx4 v11, s[8:11], s49 offen offset:3072 lds
    s_load_dword s96, s[26:27], 896
    s_load_dword s97, s[26:27], 960
    s_load_dword s98, s[26:27], 2048
    s_load_dword s99, s[26:27], 2112
    s_load_dword s96, s[26:27], 3200
    s_load_dword s97, s[26:27], 3264
    s_load_dword s98, s[26:27], 4352
    s_load_dword s99, s[26:27], 4416
    s_load_dword s96, s[26:27], 5504
    s_load_dword s97, s[26:27], 5568
    s_load_dword s98, s[26:27], 6656
    s_load_dword s99, s[26:27], 6720
    s_load_dword s96, s[26:27], 7808
    s_load_dword s97, s[26:27], 7872
    s_waitcnt vmcnt(11)
    s_barrier
    s_lshl_b32 s49, s47, 19
    s_add_u32 s49, s49, 262144
    s_add_u32 m0, s56, 147456
    s_nop 0
    buffer_load_dwordx4 v8, s[8:11], s49 offen offset:0 lds
    buffer_load_dwordx4 v9, s[8:11], s49 offen offset:1024 lds
    buffer_load_dwordx4 v10, s[8:11], s49 offen offset:2048 lds
    buffer_load_dwordx4 v11, s[8:11], s49 offen offset:3072 lds
    s_add_u32 s47, s47, 1
    s_cmp_eq_u32 s47, 9
    s_cselect_b32 s47, 0, s47
    s_lshl_b32 s48, s60, 7
    s_add_u32 m0, s58, 73728
    s_nop 0
    buffer_load_dwordx4 v12, s[4:7], s48 offen offset:0 lds
    buffer_load_dwordx4 v13, s[4:7], s48 offen offset:1024 lds
    buffer_load_dwordx4 v14, s[4:7], s48 offen offset:2048 lds
    s_add_u32 s60, s60, 1
    s_cmp_eq_u32 s60, 9
    s_cselect_b32 s60, 0, s60
    s_and_b32 s59, s44, 1
    s_cmp_eq_u32 s59, 1
    s_cbranch_scc1 HQ1
    s_waitcnt vmcnt(14)
    s_barrier
    s_lshl_b32 s49, s47, 19
    s_add_u32 m0, s56, 98304
    s_nop 0
    buffer_load_dwordx4 v8, s[8:11], s49 offen offset:0 lds
    buffer_load_dwordx4 v9, s[8:11], s49 offen offset:1024 lds
    buffer_load_dwordx4 v10, s[8:11], s49 offen offset:2048 lds
    buffer_load_dwordx4 v11, s[8:11], s49 offen offset:3072 lds
    s_load_dword s98, s[26:27], 8960
    s_load_dword s99, s[26:27], 9024
    s_load_dword s96, s[24:25], 0
    s_load_dword s97, s[24:25], 64
    s_load_dword s98, s[24:25], 1152
    s_waitcnt vmcnt(11)
    s_barrier
    s_lshl_b32 s49, s47, 19
    s_add_u32 s49, s49, 262144
    s_add_u32 m0, s56, 114688
    s_nop 0
    buffer_load_dwordx4 v8, s[8:11], s49 offen offset:0 lds
    buffer_load_dwordx4 v9, s[8:11], s49 offen offset:1024 lds
    buffer_load_dwordx4 v10, s[8:11], s49 offen offset:2048 lds
    buffer_load_dwordx4 v11, s[8:11], s49 offen offset:3072 lds
    s_add_u32 s47, s47, 1
    s_cmp_eq_u32 s47, 9
    s_cselect_b32 s47, 0, s47
    s_lshl_b32 s48, s60, 7
    s_add_u32 m0, s58, 49152
    s_nop 0
    buffer_load_dwordx4 v12, s[4:7], s48 offen offset:0 lds
    buffer_load_dwordx4 v13, s[4:7], s48 offen offset:1024 lds
    s_load_dword s99, s[24:25], 1216
    s_load_dword s96, s[24:25], 2304
    s_load_dword s97, s[24:25], 2368
    s_load_dword s98, s[24:25], 3456
    s_load_dword s99, s[24:25], 3520
    s_waitcnt vmcnt(13)
    s_barrier
    s_lshl_b32 s49, s47, 19
    s_add_u32 m0, s56, 131072
    s_nop 0
    buffer_load_dwordx4 v8, s[8:11], s49 offen offset:0 lds
    buffer_load_dwordx4 v9, s[8:11], s49 offen offset:1024 lds
    buffer_load_dwordx4 v10, s[8:11], s49 offen offset:2048 lds
    buffer_load_dwordx4 v11, s[8:11], s49 offen offset:3072 lds
    s_lshl_b32 s48, s60, 7
    s_add_u32 m0, s58, 49152
    s_nop 0
    buffer_load_dwordx4 v14, s[4:7], s48 offen offset:2048 lds
    s_add_u32 s60, s60, 1
    s_cmp_eq_u32 s60, 9
    s_cselect_b32 s60, 0, s60
    s_load_dword s96, s[24:25], 4608
    s_load_dword s97, s[24:25], 4672
    s_load_dword s98, s[24:25], 5760
    s_load_dword s99, s[24:25], 5824
    s_load_dword s96, s[24:25], 6912
    s_waitcnt vmcnt(11)
    s_barrier
    s_cmp_lg_u32 s46, 0
    s_cbranch_scc1 H_NOCNT0
    s_lshr_b32 s50, s63, 4
    s_lshl_b32 s50, s50, 4
    s_mov_b32 s100, 1
    s_atomic_add s100, s[54:55], s50
H_NOCNT0:
    s_lshl_b32 s49, s47, 19
    s_add_u32 s49, s49, 262144
    s_add_u32 m0, s56, 147456
    s_nop 0
    buffer_load_dwordx4 v8, s[8:11], s49 offen offset:0 lds
    buffer_load_dwordx4 v9, s[8:11], s49 offen offset:1024 lds
    buffer_load_dwordx4 v10, s[8:11], s49 offen offset:2048 lds
    buffer_load_dwordx4 v11, s[8:11], s49 offen offset:3072 lds
    s_add_u32 s47, s47, 1
    s_cmp_eq_u32 s47, 9
    s_cselect_b32 s47, 0, s47
    s_lshl_b32 s48, s60, 7
    s_add_u32 m0, s58, 61440
    s_nop 0
    buffer_load_dwordx4 v12, s[4:7], s48 offen offset:0 lds
    buffer_load_dwordx4 v13, s[4:7], s48 offen offset:1024 lds
    s_load_dword s97, s[24:25], 6976
    s_load_dword s98, s[24:25], 8064
    s_load_dword s99, s[24:25], 8128
    s_load_dword s96, s[24:25], 9216
    s_load_dword s97, s[24:25], 9280
    s_waitcnt vmcnt(13)
    s_barrier
    s_lshl_b32 s49, s47, 19
    s_add_u32 m0, s56, 98304
    s_nop 0
    buffer_load_dwordx4 v8, s[8:11], s49 offen offset:0 lds
    buffer_load_dwordx4 v9, s[8:11], s49 offen offset:1024 lds
    buffer_load_dwordx4 v10, s[8:11], s49 offen offset:2048 lds
    buffer_load_dwordx4 v11, s[8:11], s49 offen offset:3072 lds
    s_lshl_b32 s48, s60, 7
    s_add_u32 m0, s58, 61440
    s_nop 0
    buffer_load_dwordx4 v14, s[4:7], s48 offen offset:2048 lds
    s_add_u32 s60, s60, 1
    s_cmp_eq_u32 s60, 9
    s_cselect_b32 s60, 0, s60
    s_add_u32 m0, s56, 0
    s_nop 0
    buffer_load_dwordx4 v16, s[12:15], 0 offen offset:0 nt lds
    buffer_load_dwordx4 v17, s[12:15], 0 offen offset:1024 nt lds
    buffer_load_dwordx4 v18, s[12:15], 0 offen offset:2048 nt lds
    buffer_load_dwordx4 v19, s[12:15], 0 offen offset:3072 nt lds
    s_add_u32 m0, s56, 16384
    s_nop 0
    buffer_load_dwordx4 v16, s[12:15], s34 offen offset:0 nt lds
    buffer_load_dwordx4 v17, s[12:15], s34 offen offset:1024 nt lds
    buffer_load_dwordx4 v18, s[12:15], s34 offen offset:2048 nt lds
    buffer_load_dwordx4 v19, s[12:15], s34 offen offset:3072 nt lds
    s_add_u32 m0, s56, 32768
    s_nop 0
    buffer_load_dwordx4 v16, s[12:15], s35 offen offset:0 nt lds
    buffer_load_dwordx4 v17, s[12:15], s35 offen offset:1024 nt lds
    buffer_load_dwordx4 v18, s[12:15], s35 offen offset:2048 nt lds
    buffer_load_dwordx4 v19, s[12:15], s35 offen offset:3072 nt lds
    s_load_dword s98, s[24:25], 10368
    s_load_dword s99, s[24:25], 10432
    s_load_dword s96, s[24:25], 11520
    s_load_dword s97, s[24:25], 11584
    s_load_dword s98, s[24:25], 12672
    s_waitcnt vmcnt(23)
    s_barrier
    s_lshl_b32 s49, s47, 19
    s_add_u32 s49, s49, 262144
    s_add_u32 m0, s56, 114688
    s_nop 0
    buffer_load_dwordx4 v8, s[8:11], s49 offen offset:0 lds
    buffer_load_dwordx4 v9, s[8:11], s49 offen offset:1024 lds
    buffer_load_dwordx4 v10, s[8:11], s49 offen offset:2048 lds
    buffer_load_dwordx4 v11, s[8:11], s49 offen offset:3072 lds
    s_add_u32 s47, s47, 1
    s_cmp_eq_u32 s47, 9
    s_cselect_b32 s47, 0, s47
    s_lshl_b32 s48, s60, 7
    s_add_u32 m0, s58, 73728
    s_nop 0
    buffer_load_dwordx4 v12, s[4:7], s48 offen offset:0 lds
    buffer_load_dwordx4 v13, s[4:7], s48 offen offset:1024 lds
    s_load_dword s99, s[24:25], 12736
    s_load_dword s96, s[24:25], 13824
    s_load_dword s97, s[24:25], 13888
    s_load_dword s98, s[24:25], 14976
    s_load_dword s99, s[24:25], 15040
    s_waitcnt vmcnt(25)
    s_barrier
    s_lshl_b32 s49, s47, 19
    s_add_u32 m0, s56, 131072
    s_nop 0
    buffer_load_dwordx4 v8, s[8:11], s49 offen offset:0 lds
    buffer_load_dwordx4 v9, s[8:11], s49 offen offset:1024 lds
    buffer_load_dwordx4 v10, s[8:11], s49 offen offset:2048 lds
    buffer_load_dwordx4 v11, s[8:11], s49 offen offset:3072 lds
    s_lshl_b32 s48, s60, 7
    s_add_u32 m0, s58, 73728
    s_nop 0
    buffer_load_dwordx4 v14, s[4:7], s48 offen offset:2048 lds
    s_add_u32 s60, s60, 1
    s_cmp_eq_u32 s60, 9
    s_cselect_b32 s60, 0, s60
    s_load_dword s96, s[24:25], 16128
    s_load_dword s97, s[24:25], 16192
    s_load_dword s98, s[24:25], 17280
    s_load_dword s99, s[24:25], 17344
    s_load_dword s96, s[24:25], 18432
    s_waitcnt vmcnt(23)
    s_barrier
    s_lshl_b32 s49, s47, 19
    s_add_u32 s49, s49, 262144
    s_add_u32 m0, s56, 147456
    s_nop 0
    buffer_load_dwordx4 v8, s[8:11], s49 offen offset:0 lds
    buffer_load_dwordx4 v9, s[8:11], s49 offen offset:1024 lds
    buffer_load_dwordx4 v10, s[8:11], s49 offen offset:2048 lds
    buffer_load_dwordx4 v11, s[8:11], s49 offen offset:3072 lds
    s_add_u32 s47, s47, 1
    s_cmp_eq_u32 s47, 9
    s_cselect_b32 s47, 0, s47
    s_lshl_b32 s48, s60, 7
    s_add_u32 m0, s58, 49152
    s_nop 0
    buffer_load_dwordx4 v12, s[4:7], s48 offen offset:0 lds
    buffer_load_dwordx4 v13, s[4:7], s48 offen offset:1024 lds
    s_load_dword s97, s[24:25], 18496
    s_load_dword s98, s[24:25], 19584
    s_load_dword s99, s[24:25], 19648
    s_load_dword s96, s[24:25], 20736
    s_load_dword s97, s[24:25], 20800
    s_waitcnt vmcnt(13)
    s_barrier
    s_lshl_b32 s49, s47, 19
    s_add_u32 m0, s56, 98304
    s_nop 0
    buffer_load_dwordx4 v8, s[8:11], s49 offen offset:0 lds
    buffer_load_dwordx4 v9, s[8:11], s49 offen offset:1024 lds
    buffer_load_dwordx4 v10, s[8:11], s49 offen offset:2048 lds
    buffer_load_dwordx4 v11, s[8:11], s49 offen offset:3072 lds
    s_lshl_b32 s48, s60, 7
    s_add_u32 m0, s58, 49152
    s_nop 0
    buffer_load_dwordx4 v14, s[4:7], s48 offen offset:2048 lds
    s_add_u32 s60, s60, 1
    s_cmp_eq_u32 s60, 9
    s_cselect_b32 s60, 0, s60
    s_load_dword s98, s[24:25], 21888
    s_load_dword s99, s[24:25], 21952
    s_load_dword s96, s[24:25], 23040
    s_load_dword s97, s[24:25], 23104
    s_load_dword s98, s[24:25], 24192
    s_waitcnt vmcnt(11)
    s_barrier
    s_lshl_b32 s49, s47, 19
    s_add_u32 s49, s49, 262144
    s_add_u32 m0, s56, 114688
    s_nop 0
    buffer_load_dwordx4 v8, s[8:11], s49 offen offset:0 lds
    buffer_load_dwordx4 v9, s[8:11], s49 offen offset:1024 lds
    buffer_load_dwordx4 v10, s[8:11], s49 offen offset:2048 lds
    buffer_load_dwordx4 v11, s[8:11], s49 offen offset:3072 lds
    s_add_u32 s47, s47, 1
    s_cmp_eq_u32 s47, 9
    s_cselect_b32 s47, 0, s47
    s_lshl_b32 s48, s60, 7
    s_add_u32 m0, s58, 61440
    s_nop 0
    buffer_load_dwordx4 v12, s[4:7], s48 offen offset:0 lds
    buffer_load_dwordx4 v13, s[4:7], s48 offen offset:1024 lds
    s_load_dword s99, s[24:25], 24256
    s_load_dword s96, s[24:25], 25344
    s_load_dword s97, s[24:25], 25408
    s_load_dword s98, s[24:25], 26496
    s_load_dword s99, s[24:25], 26560
    s_waitcnt vmcnt(13)
    s_barrier
    s_lshl_b32 s49, s47, 19
    s_add_u32 m0, s56, 131072
    s_nop 0
    buffer_load_dwordx4 v8, s[8:11], s49 offen offset:0 lds
    buffer_load_dwordx4 v9, s[8:11], s49 offen offset:1024 lds
    buffer_load_dwordx4 v10, s[8:11], s49 offen offset:2048 lds
    buffer_load_dwordx4 v11, s[8:11], s49 offen offset:3072 lds
    s_lshl_b32 s48, s60, 7
    s_add_u32 m0, s58, 61440
    s_nop 0
    buffer_load_dwordx4 v14, s[4:7], s48 offen offset:2048 lds
    s_add_u32 s60, s60, 1
    s_cmp_eq_u32 s60, 9
    s_cselect_b32 s60, 0, s60
    s_load_dword s96, s[24:25], 27648
    s_load_dword s97, s[24:25], 27712
    s_load_dword s98, s[24:25], 28800
    s_load_dword s99, s[24:25], 28864
    s_load_dword s96, s[24:25], 29952
    s_waitcnt vmcnt(11)
    s_barrier
    s_lshl_b32 s49, s47, 19
    s_add_u32 s49, s49, 262144
    s_add_u32 m0, s56, 147456
    s_nop 0
    buffer_load_dwordx4 v8, s[8:11], s49 offen offset:0 lds
    buffer_load_dwordx4 v9, s[8:11], s49 offen offset:1024 lds
    buffer_load_dwordx4 v10, s[8:11], s49 offen offset:2048 lds
    buffer_load_dwordx4 v11, s[8:11], s49 offen offset:3072 lds
    s_add_u32 s47, s47, 1
    s_cmp_eq_u32 s47, 9
    s_cselect_b32 s47, 0, s47
    s_lshl_b32 s48, s60, 7
    s_add_u32 m0, s58, 73728
    s_nop 0
    buffer_load_dwordx4 v12, s[4:7], s48 offen offset:0 lds
    buffer_load_dwordx4 v13, s[4:7], s48 offen offset:1024 lds
    s_load_dword s97, s[24:25], 30016
    s_load_dword s98, s[24:25], 31104
    s_load_dword s99, s[24:25], 31168
    s_load_dword s96, s[24:25], 32256
    s_load_dword s97, s[24:25], 32320
    s_waitcnt vmcnt(13)
    s_barrier
    s_lshl_b32 s49, s47, 19
    s_add_u32 m0, s56, 98304
    s_nop 0
    buffer_load_dwordx4 v8, s[8:11], s49 offen offset:0 lds
    buffer_load_dwordx4 v9, s[8:11], s49 offen offset:1024 lds
    buffer_load_dwordx4 v10, s[8:11], s49 offen offset:2048 lds
    buffer_load_dwordx4 v11, s[8:11], s49 offen offset:3072 lds
    s_lshl_b32 s48, s60, 7
    s_add_u32 m0, s58, 73728
    s_nop 0
    buffer_load_dwordx4 v14, s[4:7], s48 offen offset:2048 lds
    s_add_u32 s60, s60, 1
    s_cmp_eq_u32 s60, 9
    s_cselect_b32 s60, 0, s60
    s_load_dword s98, s[24:25], 33408
    s_load_dword s99, s[24:25], 33472
    s_load_dword s96, s[24:25], 34560
    s_load_dword s97, s[24:25], 34624
    s_load_dword s98, s[24:25], 35712
    s_waitcnt vmcnt(11)
    s_barrier
    s_lshl_b32 s49, s47, 19
    s_add_u32 s49, s49, 262144
    s_add_u32 m0, s56, 114688
    s_nop 0
    buffer_load_dwordx4 v8, s[8:11], s49 offen offset:0 lds
    buffer_load_dwordx4 v9, s[8:11], s49 offen offset:1024 lds
    buffer_load_dwordx4 v10, s[8:11], s49 offen offset:2048 lds
    buffer_load_dwordx4 v11, s[8:11], s49 offen offset:3072 lds
    s_add_u32 s47, s47, 1
    s_cmp_eq_u32 s47, 9
    s_cselect_b32 s47, 0, s47
    s_waitcnt vmcnt(11)
    s_barrier
    s_add_u32 m0, s56, 131072
    s_nop 0
    buffer_load_dwordx4 v20, s[16:19], 0 offen offset:0 nt lds
    buffer_load_dwordx4 v21, s[16:19], 0 offen offset:1024 nt lds
    buffer_load_dwordx4 v20, s[16:19], 0 offen offset:2048 nt lds
    buffer_load_dwordx4 v21, s[16:19], 0 offen offset:3072 nt lds
    s_waitcnt vmcnt(8)
    s_barrier
    s_add_u32 m0, s56, 147456
    s_nop 0
    buffer_load_dwordx4 v20, s[16:19], s34 offen offset:0 nt lds
    buffer_load_dwordx4 v21, s[16:19], s34 offen offset:1024 nt lds
    buffer_load_dwordx4 v20, s[16:19], s34 offen offset:2048 nt lds
    buffer_load_dwordx4 v21, s[16:19], s34 offen offset:3072 nt lds
    s_waitcnt vmcnt(8)
    s_barrier
    s_add_u32 m0, s56, 98304
    s_nop 0
    buffer_load_dwordx4 v20, s[16:19], s35 offen offset:0 nt lds
    buffer_load_dwordx4 v21, s[16:19], s35 offen offset:1024 nt lds
    buffer_load_dwordx4 v20, s[16:19], s35 offen offset:2048 nt lds
    buffer_load_dwordx4 v21, s[16:19], s35 offen offset:3072 nt lds
    s_branch HQ_END
HQ1:
    s_waitcnt vmcnt(14)
    s_barrier
    s_lshl_b32 s49, s47, 19
    s_add_u32 m0, s56, 98304
    s_nop 0
    buffer_load_dwordx4 v8, s[8:11], s49 offen offset:0 lds
    buffer_load_dwordx4 v9, s[8:11], s49 offen offset:1024 lds
    buffer_load_dwordx4 v10, s[8:11], s49 offen offset:2048 lds
    buffer_load_dwordx4 v11, s[8:11], s49 offen offset:3072 lds
    s_load_dword s98, s[26:27], 8960
    s_load_dword s99, s[26:27], 9024
    s_load_dword s96, s[24:25], 0
    s_load_dword s97, s[24:25], 64
    s_load_dword s98, s[24:25], 1152
    s_waitcnt vmcnt(11)
    s_barrier
    s_lshl_b32 s49, s47, 19
    s_add_u32 s49, s49, 262144
    s_add_u32 m0, s56, 114688
    s_nop 0
    buffer_load_dwordx4 v8, s[8:11], s49 offen offset:0 lds
    buffer_load_dwordx4 v9, s[8:11], s49 offen offset:1024 lds
    buffer_load_dwordx4 v10, s[8:11], s49 offen offset:2048 lds
    buffer_load_dwordx4 v11, s[8:11], s49 offen offset:3072 lds
    s_add_u32 s47, s47, 1
    s_cmp_eq_u32 s47, 9
    s_cselect_b32 s47, 0, s47
    s_lshl_b32 s48, s60, 7
    s_add_u32 m0, s58, 49152
    s_nop 0
    buffer_load_dwordx4 v12, s[4:7], s48 offen offset:0 lds
    buffer_load_dwordx4 v13, s[4:7], s48 offen offset:1024 lds
    s_load_dword s99, s[24:25], 1216
    s_load_dword s96, s[24:25], 2304
    s_load_dword s97, s[24:25], 2368
    s_load_dword s98, s[24:25], 3456
    s_load_dword s99, s[24:25], 3520
    s_waitcnt vmcnt(13)
    s_barrier
    s_lshl_b32 s49, s47, 19
    s_add_u32 m0, s56, 131072
    s_nop 0
    buffer_load_dwordx4 v8, s[8:11], s49 offen offset:0 lds
    buffer_load_dwordx4 v9, s[8:11], s49 offen offset:1024 lds
    buffer_load_dwordx4 v10, s[8:11], s49 offen offset:2048 lds
    buffer_load_dwordx4 v11, s[8:11], s49 offen offset:3072 lds
    s_lshl_b32 s48, s60, 7
    s_add_u32 m0, s58, 49152
    s_nop 0
    buffer_load_dwordx4 v14, s[4:7], s48 offen offset:2048 lds
    s_add_u32 s60, s60, 1
    s_cmp_eq_u32 s60, 9
    s_cselect_b32 s60, 0, s60
    s_load_dword s96, s[24:25], 4608
    s_load_dword s97, s[24:25], 4672
    s_load_dword s98, s[24:25], 5760
    s_load_dword s99, s[24:25], 5824
    s_load_dword s96, s[24:25], 6912
    s_waitcnt vmcnt(11)
    s_barrier
    s_cmp_lg_u32 s46, 0
    s_cbranch_scc1 H_NOCNT1
    s_lshr_b32 s50, s63, 4
    s_lshl_b32 s50, s50, 4
    s_mov_b32 s100, 1
    s_atomic_add s100, s[54:55], s50
H_NOCNT1:
    s_lshl_b32 s49, s47, 19
    s_add_u32 s49, s49, 262144
    s_add_u32 m0, s56, 147456
    s_nop 0
    buffer_load_dwordx4 v8, s[8:11], s49 offen offset:0 lds
    buffer_load_dwordx4 v9, s[8:11], s49 offen offset:1024 lds
    buffer_load_dwordx4 v10, s[8:11], s49 offen offset:2048 lds
    buffer_load_dwordx4 v11, s[8:11], s49 offen offset:3072 lds
    s_add_u32 s47, s47, 1
    s_cmp_eq_u32 s47, 9
    s_cselect_b32 s47, 0, s47
    s_lshl_b32 s48, s60, 7
    s_add_u32 m0, s58, 61440
    s_nop 0
    buffer_load_dwordx4 v12, s[4:7], s48 offen offset:0 lds
    buffer_load_dwordx4 v13, s[4:7], s48 offen offset:1024 lds
    s_load_dword s97, s[24:25], 6976
    s_load_dword s98, s[24:25], 8064
    s_load_dword s99, s[24:25], 8128
    s_load_dword s96, s[24:25], 9216
    s_load_dword s97, s[24:25], 9280
    s_waitcnt vmcnt(13)
    s_barrier
    s_lshl_b32 s49, s47, 19
    s_add_u32 m0, s56, 98304
    s_nop 0
    buffer_load_dwordx4 v8, s[8:11], s49 offen offset:0 lds
    buffer_load_dwordx4 v9, s[8:11], s49 offen offset:1024 lds
    buffer_load_dwordx4 v10, s[8:11], s49 offen offset:2048 lds
    buffer_load_dwordx4 v11, s[8:11], s49 offen offset:3072 lds
    s_lshl_b32 s48, s60, 7
    s_add_u32 m0, s58, 61440
    s_nop 0
    buffer_load_dwordx4 v14, s[4:7], s48 offen offset:2048 lds
    s_add_u32 s60, s60, 1
    s_cmp_eq_u32 s60, 9
    s_cselect_b32 s60, 0, s60
    s_load_dword s98, s[24:25], 10368
    s_load_dword s99, s[24:25], 10432
    s_load_dword s96, s[24:25], 11520
    s_load_dword s97, s[24:25], 11584
    s_load_dword s98, s[24:25], 12672
    s_waitcnt vmcnt(11)
    s_barrier
    s_lshl_b32 s49, s47, 19
    s_add_u32 s49, s49, 262144
    s_add_u32 m0, s56, 114688
    s_nop 0
    buffer_load_dwordx4 v8, s[8:11], s49 offen offset:0 lds
    buffer_load_dwordx4 v9, s[8:11], s49 offen offset:1024 lds
    buffer_load_dwordx4 v10, s[8:11], s49 offen offset:2048 lds
    buffer_load_dwordx4 v11, s[8:11], s49 offen offset:3072 lds
    s_add_u32 s47, s47, 1
    s_cmp_eq_u32 s47, 9
    s_cselect_b32 s47, 0, s47
    s_lshl_b32 s48, s60, 7
    s_add_u32 m0, s58, 73728
    s_nop 0
    buffer_load_dwordx4 v12, s[4:7], s48 offen offset:0 lds
    buffer_load_dwordx4 v13, s[4:7], s48 offen offset:1024 lds
    s_load_dword s99, s[24:25], 12736
    s_load_dword s96, s[24:25], 13824
    s_load_dword s97, s[24:25], 13888
    s_load_dword s98, s[24:25], 14976
    s_load_dword s99, s[24:25], 15040
    s_waitcnt vmcnt(13)
    s_barrier
    s_lshl_b32 s49, s47, 19
    s_add_u32 m0, s56, 131072
    s_nop 0
    buffer_load_dwordx4 v8, s[8:11], s49 offen offset:0 lds
    buffer_load_dwordx4 v9, s[8:11], s49 offen offset:1024 lds
    buffer_load_dwordx4 v10, s[8:11], s49 offen offset:2048 lds
    buffer_load_dwordx4 v11, s[8:11], s49 offen offset:3072 lds
    s_lshl_b32 s48, s60, 7
    s_add_u32 m0, s58, 73728
    s_nop 0
    buffer_load_dwordx4 v14, s[4:7], s48 offen offset:2048 lds
    s_add_u32 s60, s60, 1
    s_cmp_eq_u32 s60, 9
    s_cselect_b32 s60, 0, s60
    s_load_dword s96, s[24:25], 16128
    s_load_dword s97, s[24:25], 16192
    s_load_dword s98, s[24:25], 17280
    s_load_dword s99, s[24:25], 17344
    s_load_dword s96, s[24:25], 18432
    s_waitcnt vmcnt(11)
    s_barrier
    s_lshl_b32 s49, s47, 19
    s_add_u32 s49, s49, 262144
    s_add_u32 m0, s56, 147456
    s_nop 0
    buffer_load_dwordx4 v8, s[8:11], s49 offen offset:0 lds
    buffer_load_dwordx4 v9, s[8:11], s49 offen offset:1024 lds
    buffer_load_dwordx4 v10, s[8:11], s49 offen offset:2048 lds
    buffer_load_dwordx4 v11, s[8:11], s49 offen offset:3072 lds
    s_add_u32 s47, s47, 1
    s_cmp_eq_u32 s47, 9
    s_cselect_b32 s47, 0, s47
    s_lshl_b32 s48, s60, 7
    s_add_u32 m0, s58, 49152
    s_nop 0
    buffer_load_dwordx4 v12, s[4:7], s48 offen offset:0 lds
    buffer_load_dwordx4 v13, s[4:7], s48 offen offset:1024 lds
    s_load_dword s97, s[24:25], 18496
    s_load_dword s98, s[24:25], 19584
    s_load_dword s99, s[24:25], 19648
    s_load_dword s96, s[24:25], 20736
    s_load_dword s97, s[24:25], 20800
    s_waitcnt vmcnt(13)
    s_barrier
    s_lshl_b32 s49, s47, 19
    s_add_u32 m0, s56, 98304
    s_nop 0
    buffer_load_dwordx4 v8, s[8:11], s49 offen offset:0 lds
    buffer_load_dwordx4 v9, s[8:11], s49 offen offset:1024 lds
    buffer_load_dwordx4 v10, s[8:11], s49 offen offset:2048 lds
    buffer_load_dwordx4 v11, s[8:11], s49 offen offset:3072 lds
    s_lshl_b32 s48, s60, 7
    s_add_u32 m0, s58, 49152
    s_nop 0
    buffer_load_dwordx4 v14, s[4:7], s48 offen offset:2048 lds
    s_add_u32 s60, s60, 1
    s_cmp_eq_u32 s60, 9
    s_cselect_b32 s60, 0, s60
    s_load_dword s98, s[24:25], 21888
    s_load_dword s99, s[24:25], 21952
    s_load_dword s96, s[24:25], 23040
    s_load_dword s97, s[24:25], 23104
    s_load_dword s98, s[24:25], 24192
    s_waitcnt vmcnt(11)
    s_barrier
    s_lshl_b32 s49, s47, 19
    s_add_u32 s49, s49, 262144
    s_add_u32 m0, s56, 114688
    s_nop 0
    buffer_load_dwordx4 v8, s[8:11], s49 offen offset:0 lds
    buffer_load_dwordx4 v9, s[8:11], s49 offen offset:1024 lds
    buffer_load_dwordx4 v10, s[8:11], s49 offen offset:2048 lds
    buffer_load_dwordx4 v11, s[8:11], s49 offen offset:3072 lds
    s_add_u32 s47, s47, 1
    s_cmp_eq_u32 s47, 9
    s_cselect_b32 s47, 0, s47
    s_lshl_b32 s48, s60, 7
    s_add_u32 m0, s58, 61440
    s_nop 0
    buffer_load_dwordx4 v12, s[4:7], s48 offen offset:0 lds
    buffer_load_dwordx4 v13, s[4:7], s48 offen offset:1024 lds
    s_add_u32 m0, s56, 0
    s_nop 0
    buffer_load_dwordx4 v16, s[12:15], 0 offen offset:0 nt lds
    buffer_load_dwordx4 v17, s[12:15], 0 offen offset:1024 nt lds
    buffer_load_dwordx4 v18, s[12:15], 0 offen offset:2048 nt lds
    buffer_load_dwordx4 v19, s[12:15], 0 offen offset:3072 nt lds
    s_add_u32 m0, s56, 16384
    s_nop 0
    buffer_load_dwordx4 v16, s[12:15], s34 offen offset:0 nt lds
    buffer_load_dwordx4 v17, s[12:15], s34 offen offset:1024 nt lds
    buffer_load_dwordx4 v18, s[12:15], s34 offen offset:2048 nt lds
    buffer_load_dwordx4 v19, s[12:15], s34 offen offset:3072 nt lds
    s_add_u32 m0, s56, 32768
    s_nop 0
    buffer_load_dwordx4 v16, s[12:15], s35 offen offset:0 nt lds
    buffer_load_dwordx4 v17, s[12:15], s35 offen offset:1024 nt lds
    buffer_load_dwordx4 v18, s[12:15], s35 offen offset:2048 nt lds
    buffer_load_dwordx4 v19, s[12:15], s35 offen offset:3072 nt lds
    s_load_dword s99, s[24:25], 24256
    s_load_dword s96, s[24:25], 25344
    s_load_dword s97, s[24:25], 25408
    s_load_dword s98, s[24:25], 26496
    s_load_dword s99, s[24:25], 26560
    s_waitcnt vmcnt(25)
    s_barrier
    s_lshl_b32 s49, s47, 19
    s_add_u32 m0, s56, 131072
    s_nop 0
    buffer_load_dwordx4 v8, s[8:11], s49 offen offset:0 lds
    buffer_load_dwordx4 v9, s[8:11], s49 offen offset:1024 lds
    buffer_load_dwordx4 v10, s[8:11], s49 offen offset:2048 lds
    buffer_load_dwordx4 v11, s[8:11], s49 offen offset:3072 lds
    s_lshl_b32 s48, s60, 7
    s_add_u32 m0, s58, 61440
    s_nop 0
    buffer_load_dwordx4 v14, s[4:7], s48 offen offset:2048 lds
    s_add_u32 s60, s60, 1
    s_cmp_eq_u32 s60, 9
    s_cselect_b32 s60, 0, s60
    s_load_dword s96, s[24:25], 27648
    s_load_dword s97, s[24:25], 27712
    s_load_dword s98, s[24:25], 28800
    s_load_dword s99, s[24:25], 28864
    s_load_dword s96, s[24:25], 29952
    s_waitcnt vmcnt(23)
    s_barrier
    s_lshl_b32 s49, s47, 19
    s_add_u32 s49, s49, 262144
    s_add_u32 m0, s56, 147456
    s_nop 0
    buffer_load_dwordx4 v8, s[8:11], s49 offen offset:0 lds
    buffer_load_dwordx4 v9, s[8:11], s49 offen offset:1024 lds
    buffer_load_dwordx4 v10, s[8:11], s49 offen offset:2048 lds
    buffer_load_dwordx4 v11, s[8:11], s49 offen offset:3072 lds
    s_add_u32 s47, s47, 1
    s_cmp_eq_u32 s47, 9
    s_cselect_b32 s47, 0, s47
    s_lshl_b32 s48, s60, 7
    s_add_u32 m0, s58, 73728
    s_nop 0
    buffer_load_dwordx4 v12, s[4:7], s48 offen offset:0 lds
    buffer_load_dwordx4 v13, s[4:7], s48 offen offset:1024 lds
    s_load_dword s97, s[24:25], 30016
    s_load_dword s98, s[24:25], 31104
    s_load_dword s99, s[24:25], 31168
    s_load_dword s96, s[24:25], 32256
    s_load_dword s97, s[24:25], 32320
    s_waitcnt vmcnt(25)
    s_barrier
    s_lshl_b32 s49, s47, 19
    s_add_u32 m0, s56, 98304
    s_nop 0
    buffer_load_dwordx4 v8, s[8:11], s49 offen offset:0 lds
    buffer_load_dwordx4 v9, s[8:11], s49 offen offset:1024 lds
    buffer_load_dwordx4 v10, s[8:11], s49 offen offset:2048 lds
    buffer_load_dwordx4 v11, s[8:11], s49 offen offset:3072 lds
    s_lshl_b32 s48, s60, 7
    s_add_u32 m0, s58, 73728
    s_nop 0
    buffer_load_dwordx4 v14, s[4:7], s48 offen offset:2048 lds
    s_add_u32 s60, s60, 1
    s_cmp_eq_u32 s60, 9
    s_cselect_b32 s60, 0, s60
    s_load_dword s98, s[24:25], 33408
    s_load_dword s99, s[24:25], 33472
    s_load_dword s96, s[24:25], 34560
    s_load_dword s97, s[24:25], 34624
    s_load_dword s98, s[24:25], 35712
    s_waitcnt vmcnt(11)
    s_barrier
    s_lshl_b32 s49, s47, 19
    s_add_u32 s49, s49, 262144
    s_add_u32 m0, s56, 114688
    s_nop 0
    buffer_load_dwordx4 v8, s[8:11], s49 offen offset:0 lds
    buffer_load_dwordx4 v9, s[8:11], s49 offen offset:1024 lds
    buffer_load_dwordx4 v10, s[8:11], s49 offen offset:2048 lds
    buffer_load_dwordx4 v11, s[8:11], s49 offen offset:3072 lds
    s_add_u32 s47, s47, 1
    s_cmp_eq_u32 s47, 9
    s_cselect_b32 s47, 0, s47
    s_waitcnt vmcnt(11)
    s_barrier
    s_add_u32 m0, s56, 131072
    s_nop 0
    buffer_load_dwordx4 v20, s[16:19], 0 offen offset:0 nt lds
    buffer_load_dwordx4 v21, s[16:19], 0 offen offset:1024 nt lds
    buffer_load_dwordx4 v20, s[16:19], 0 offen offset:2048 nt lds
    buffer_load_dwordx4 v21, s[16:19], 0 offen offset:3072 nt lds
    s_waitcnt vmcnt(8)
    s_barrier
    s_add_u32 m0, s56, 147456
    s_nop 0
    buffer_load_dwordx4 v20, s[16:19], s34 offen offset:0 nt lds
    buffer_load_dwordx4 v21, s[16:19], s34 offen offset:1024 nt lds
    buffer_load_dwordx4 v20, s[16:19], s34 offen offset:2048 nt lds
    buffer_load_dwordx4 v21, s[16:19], s34 offen offset:3072 nt lds
    s_waitcnt vmcnt(8)
    s_barrier
    s_add_u32 m0, s56, 98304
    s_nop 0
    buffer_load_dwordx4 v20, s[16:19], s35 offen offset:0 nt lds
    buffer_load_dwordx4 v21, s[16:19], s35 offen offset:1024 nt lds
    buffer_load_dwordx4 v20, s[16:19], s35 offen offset:2048 nt lds
    buffer_load_dwordx4 v21, s[16:19], s35 offen offset:3072 nt lds
HQ_END:
    s_barrier
    buffer_load_dword v33, v36, s[36:39], 0 offen sc0 sc1
    s_add_u32 s48, s84, s32
    s_add_u32 s49, s48, 36864
    s_add_u32 m0, s57, 65536
    s_nop 0
    buffer_load_dwordx4 v24, s[20:23], s48 offen offset:0 lds
    buffer_load_dwordx4 v25, s[20:23], s48 offen offset:1024 lds
    buffer_load_dwordx4 v26, s[20:23], s48 offen offset:2048 lds
    buffer_load_dwordx4 v27, s[20:23], s48 offen offset:3072 lds
    s_add_u32 m0, s57, 69632
    s_nop 0
    buffer_load_dwordx4 v24, s[20:23], s49 offen offset:0 lds
    buffer_load_dwordx4 v25, s[20:23], s49 offen offset:1024 lds
    buffer_load_dwordx4 v26, s[20:23], s49 offen offset:2048 lds
    buffer_load_dwordx4 v27, s[20:23], s49 offen offset:3072 lds
    s_waitcnt vmcnt(9)
    s_barrier
    s_barrier
    s_add_u32 s48, s85, s32
    s_add_u32 s49, s48, 36864
    s_add_u32 m0, s57, 32768
    s_nop 0
    buffer_load_dwordx4 v24, s[20:23], s48 offen offset:0 lds
    buffer_load_dwordx4 v25, s[20:23], s48 offen offset:1024 lds
    buffer_load_dwordx4 v26, s[20:23], s48 offen offset:2048 lds
    buffer_load_dwordx4 v27, s[20:23], s48 offen offset:3072 lds
    s_add_u32 m0, s57, 36864
    s_nop 0
    buffer_load_dwordx4 v24, s[20:23], s49 offen offset:0 lds
    buffer_load_dwordx4 v25, s[20:23], s49 offen offset:1024 lds
    buffer_load_dwordx4 v26, s[20:23], s49 offen offset:2048 lds
    buffer_load_dwordx4 v27, s[20:23], s49 offen offset:3072 lds
    s_add_u32 s48, s86, s32
    s_add_u32 s49, s48, 36864
    s_add_u32 m0, s57, 98304
    s_nop 0
    buffer_load_dwordx4 v24, s[20:23], s48 offen offset:0 lds
    buffer_load_dwordx4 v25, s[20:23], s48 offen offset:1024 lds
    buffer_load_dwordx4 v26, s[20:23], s48 offen offset:2048 lds
    buffer_load_dwordx4 v27, s[20:23], s48 offen offset:3072 lds
    s_add_u32 m0, s57, 102400
    s_nop 0
    buffer_load_dwordx4 v24, s[20:23], s49 offen offset:0 lds
    buffer_load_dwordx4 v25, s[20:23], s49 offen offset:1024 lds
    buffer_load_dwordx4 v26, s[20:23], s49 offen offset:2048 lds
    buffer_load_dwordx4 v27, s[20:23], s49 offen offset:3072 lds
    s_waitcnt vmcnt(16)
    s_barrier
    v_cmp_gt_u32 vcc, 16, v33
    s_nop 1
    s_cbranch_vccz HC_GO
    s_mov_b32 s59, 0
HC_POLL:
    buffer_load_dword v33, v36, s[36:39], 0 offen sc0 sc1
    s_waitcnt vmcnt(0)
    v_cmp_gt_u32 vcc, 16, v33
    s_add_u32 s59, s59, 1
    s_nop 0
    s_cbranch_vccz HC_GO
    s_sleep 1
    s_cmp_lt_u32 s59, 0x40000
    s_cbranch_scc1 HC_POLL
HC_GO:
    s_add_u32 s48, s87, s32
    s_add_u32 s49, s48, 36864
    s_add_u32 m0, s57, 131072
    s_nop 0
    buffer_load_dwordx4 v24, s[20:23], s48 offen offset:0 lds
    buffer_load_dwordx4 v25, s[20:23], s48 offen offset:1024 lds
    buffer_load_dwordx4 v26, s[20:23], s48 offen offset:2048 lds
    buffer_load_dwordx4 v27, s[20:23], s48 offen offset:3072 lds
    s_add_u32 m0, s57, 135168
    s_nop 0
    buffer_load_dwordx4 v24, s[20:23], s49 offen offset:0 lds
    buffer_load_dwordx4 v25, s[20:23], s49 offen offset:1024 lds
    buffer_load_dwordx4 v26, s[20:23], s49 offen offset:2048 lds
    buffer_load_dwordx4 v27, s[20:23], s49 offen offset:3072 lds
    s_lshl_b32 s24, s63, 7
    s_add_u32 s24, s24, 19283968
    s_xor_b32 s25, s24, 128
    s_lshl_b32 s26, s42, 4
    s_add_u32 s26, s26, s62
    s_mul_i32 s26, s26, 4608
    s_lshl_b32 s27, s46, 7
    s_add_u32 s26, s26, s27
    s_add_u32 s26, s26, 19136512
    s_lshl_b32 s27, s46, 2
    s_add_u32 s27, s27, 24576
    v_mov_b32 v37, s27
    v_mov_b32 v38, 0
    ds_write_b32 v37, v38
    s_mov_b32 s100, 1
    s_waitcnt vmcnt(16)
    s_barrier
    s_add_u32 s48, s88, s32
    s_add_u32 s49, s48, 36864
    s_add_u32 m0, s57, 65536
    s_nop 0
    buffer_load_dwordx4 v24, s[20:23], s48 offen offset:0 lds
    buffer_load_dwordx4 v25, s[20:23], s48 offen offset:1024 lds
    buffer_load_dwordx4 v26, s[20:23], s48 offen offset:2048 lds
    buffer_load_dwordx4 v27, s[20:23], s48 offen offset:3072 lds
    s_add_u32 m0, s57, 69632
    s_nop 0
    buffer_load_dwordx4 v24, s[20:23], s49 offen offset:0 lds
    buffer_load_dwordx4 v25, s[20:23], s49 offen offset:1024 lds
    buffer_load_dwordx4 v26, s[20:23], s49 offen offset:2048 lds
    buffer_load_dwordx4 v27, s[20:23], s49 offen offset:3072 lds
    s_waitcnt vmcnt(16)
    s_barrier
    s_cmp_lg_u32 s46, 0
    s_cbranch_scc1 H_NOG
    s_atomic_add s100, s[40:41], s24
H_NOG:
    s_waitcnt vmcnt(8)
    s_barrier
    s_add_u32 s48, s89, s32
    s_add_u32 s49, s48, 36864
    s_add_u32 m0, s57, 98304
    s_nop 0
    buffer_load_dwordx4 v24, s[20:23], s48 offen offset:0 lds
    buffer_load_dwordx4 v25, s[20:23], s48 offen offset:1024 lds
    buffer_load_dwordx4 v26, s[20:23], s48 offen offset:2048 lds
    buffer_load_dwordx4 v27, s[20:23], s48 offen offset:3072 lds
    s_add_u32 m0, s57, 102400
    s_nop 0
    buffer_load_dwordx4 v24, s[20:23], s49 offen offset:0 lds
    buffer_load_dwordx4 v25, s[20:23], s49 offen offset:1024 lds
    buffer_load_dwordx4 v26, s[20:23], s49 offen offset:2048 lds
    buffer_load_dwordx4 v27, s[20:23], s49 offen offset:3072 lds
    s_waitcnt vmcnt(8)
    s_barrier
    s_load_dword s101, s[40:41], s25 glc
    s_add_u32 s48, s90, s32
    s_add_u32 s49, s48, 36864
    s_add_u32 m0, s57, 131072
    s_nop 0
    buffer_load_dwordx4 v24, s[20:23], s48 offen offset:0 lds
    buffer_load_dwordx4 v25, s[20:23], s48 offen offset:1024 lds
    buffer_load_dwordx4 v26, s[20:23], s48 offen offset:2048 lds
    buffer_load_dwordx4 v27, s[20:23], s48 offen offset:3072 lds
    s_add_u32 m0, s57, 135168
    s_nop 0
    buffer_load_dwordx4 v24, s[20:23], s49 offen offset:0 lds
    buffer_load_dwordx4 v25, s[20:23], s49 offen offset:1024 lds
    buffer_load_dwordx4 v26, s[20:23], s49 offen offset:2048 lds
    buffer_load_dwordx4 v27, s[20:23], s49 offen offset:3072 lds
    s_waitcnt vmcnt(8)
    s_barrier
    s_mov_b32 s59, 0
HP_POLL:
    s_waitcnt lgkmcnt(0)
    s_cmp_ge_u32 s101, 1
    s_cbranch_scc1 HP_GO
    s_load_dword s101, s[40:41], s25 glc
    s_add_u32 s59, s59, 1
    s_cmp_lt_u32 s59, 0x40000
    s_cbranch_scc1 HP_POLL
HP_GO:
    s_mul_i32 s48, s46, 6144
    s_add_u32 s48, s48, 32768
    s_mov_b32 m0, s48
    s_nop 0
    buffer_load_dwordx4 v35, s[28:31], 0 offen offset:0 sc0 sc1 lds
    buffer_load_dwordx4 v35, s[28:31], 0 offen offset:1024 sc0 sc1 lds
    buffer_load_dwordx4 v35, s[28:31], 0 offen offset:2048 sc0 sc1 lds
    buffer_load_dwordx4 v35, s[28:31], 0 offen offset:3072 sc0 sc1 lds
    s_add_u32 m0, s48, 4096
    s_nop 0
    buffer_load_dwordx4 v35, s[28:31], s34 offen offset:0 sc0 sc1 lds
    buffer_load_dwordx4 v35, s[28:31], s34 offen offset:1024 sc0 sc1 lds
    s_add_u32 s48, s91, s32
    s_add_u32 s49, s48, 36864
    s_add_u32 m0, s57, 65536
    s_nop 0
    buffer_load_dwordx4 v24, s[20:23], s48 offen offset:0 lds
    buffer_load_dwordx4 v25, s[20:23], s48 offen offset:1024 lds
    buffer_load_dwordx4 v26, s[20:23], s48 offen offset:2048 lds
    buffer_load_dwordx4 v27, s[20:23], s48 offen offset:3072 lds
    s_add_u32 m0, s57, 69632
    s_nop 0
    buffer_load_dwordx4 v24, s[20:23], s49 offen offset:0 lds
    buffer_load_dwordx4 v25, s[20:23], s49 offen offset:1024 lds
    buffer_load_dwordx4 v26, s[20:23], s49 offen offset:2048 lds
    buffer_load_dwordx4 v27, s[20:23], s49 offen offset:3072 lds
    s_waitcnt vmcnt(14)
    s_barrier
    s_add_u32 s48, s84, s33
    s_add_u32 s49, s48, 36864
    s_add_u32 m0, s57, 98304
    s_nop 0
    buffer_load_dwordx4 v24, s[20:23], s48 offen offset:0 lds
    buffer_load_dwordx4 v25, s[20:23], s48 offen offset:1024 lds
    buffer_load_dwordx4 v26, s[20:23], s48 offen offset:2048 lds
    buffer_load_dwordx4 v27, s[20:23], s48 offen offset:3072 lds
    s_add_u32 m0, s57, 102400
    s_nop 0
    buffer_load_dwordx4 v24, s[20:23], s49 offen offset:0 lds
    buffer_load_dwordx4 v25, s[20:23], s49 offen offset:1024 lds
    buffer_load_dwordx4 v26, s[20:23], s49 offen offset:2048 lds
    buffer_load_dwordx4 v27, s[20:23], s49 offen offset:3072 lds
    s_waitcnt vmcnt(8)
    s_barrier
    s_add_u32 s48, s85, s33
    s_add_u32 s49, s48, 36864
    s_add_u32 m0, s57, 131072
    s_nop 0
    buffer_load_dwordx4 v24, s[20:23], s48 offen offset:0 lds
    buffer_load_dwordx4 v25, s[20:23], s48 offen offset:1024 lds
    buffer_load_dwordx4 v26, s[20:23], s48 offen offset:2048 lds
    buffer_load_dwordx4 v27, s[20:23], s48 offen offset:3072 lds
    s_add_u32 m0, s57, 135168
    s_nop 0
    buffer_load_dwordx4 v24, s[20:23], s49 offen offset:0 lds
    buffer_load_dwordx4 v25, s[20:23], s49 offen offset:1024 lds
    buffer_load_dwordx4 v26, s[20:23], s49 offen offset:2048 lds
    buffer_load_dwordx4 v27, s[20:23], s49 offen offset:3072 lds
    s_waitcnt vmcnt(8)
    s_barrier
    s_add_u32 s48, s86, s33
    s_add_u32 s49, s48, 36864
    s_add_u32 m0, s57, 65536
    s_nop 0
    buffer_load_dwordx4 v24, s[20:23], s48 offen offset:0 lds
    buffer_load_dwordx4 v25, s[20:23], s48 offen offset:1024 lds
    buffer_load_dwordx4 v26, s[20:23], s48 offen offset:2048 lds
    buffer_load_dwordx4 v27, s[20:23], s48 offen offset:3072 lds
    s_add_u32 m0, s57, 69632
    s_nop 0
    buffer_load_dwordx4 v24, s[20:23], s49 offen offset:0 lds
    buffer_load_dwordx4 v25, s[20:23], s49 offen offset:1024 lds
    buffer_load_dwordx4 v26, s[20:23], s49 offen offset:2048 lds
    buffer_load_dwordx4 v27, s[20:23], s49 offen offset:3072 lds
    s_waitcnt vmcnt(8)
    s_barrier
    s_add_u32 s48, s87, s33
    s_add_u32 s49, s48, 36864
    s_add_u32 m0, s57, 98304
    s_nop 0
    buffer_load_dwordx4 v24, s[20:23], s48 offen offset:0 lds
    buffer_load_dwordx4 v25, s[20:23], s48 offen offset:1024 lds
    buffer_load_dwordx4 v26, s[20:23], s48 offen offset:2048 lds
    buffer_load_dwordx4 v27, s[20:23], s48 offen offset:3072 lds
    s_add_u32 m0, s57, 102400
    s_nop 0
    buffer_load_dwordx4 v24, s[20:23], s49 offen offset:0 lds
    buffer_load_dwordx4 v25, s[20:23], s49 offen offset:1024 lds
    buffer_load_dwordx4 v26, s[20:23], s49 offen offset:2048 lds
    buffer_load_dwordx4 v27, s[20:23], s49 offen offset:3072 lds
    s_waitcnt vmcnt(8)
    s_barrier
    s_add_u32 s48, s88, s33
    s_add_u32 s49, s48, 36864
    s_add_u32 m0, s57, 131072
    s_nop 0
    buffer_load_dwordx4 v24, s[20:23], s48 offen offset:0 lds
    buffer_load_dwordx4 v25, s[20:23], s48 offen offset:1024 lds
    buffer_load_dwordx4 v26, s[20:23], s48 offen offset:2048 lds
    buffer_load_dwordx4 v27, s[20:23], s48 offen offset:3072 lds
    s_add_u32 m0, s57, 135168
    s_nop 0
    buffer_load_dwordx4 v24, s[20:23], s49 offen offset:0 lds
    buffer_load_dwordx4 v25, s[20:23], s49 offen offset:1024 lds
    buffer_load_dwordx4 v26, s[20:23], s49 offen offset:2048 lds
    buffer_load_dwordx4 v27, s[20:23], s49 offen offset:3072 lds
    s_waitcnt vmcnt(8)
    s_barrier
    s_add_u32 s48, s89, s33
    s_add_u32 s49, s48, 36864
    s_add_u32 m0, s57, 65536
    s_nop 0
    buffer_load_dwordx4 v24, s[20:23], s48 offen offset:0 lds
    buffer_load_dwordx4 v25, s[20:23], s48 offen offset:1024 lds
    buffer_load_dwordx4 v26, s[20:23], s48 offen offset:2048 lds
    buffer_load_dwordx4 v27, s[20:23], s48 offen offset:3072 lds
    s_add_u32 m0, s57, 69632
    s_nop 0
    buffer_load_dwordx4 v24, s[20:23], s49 offen offset:0 lds
    buffer_load_dwordx4 v25, s[20:23], s49 offen offset:1024 lds
    buffer_load_dwordx4 v26, s[20:23], s49 offen offset:2048 lds
    buffer_load_dwordx4 v27, s[20:23], s49 offen offset:3072 lds
    s_waitcnt vmcnt(8)
    s_barrier
    s_add_u32 s48, s90, s33
    s_add_u32 s49, s48, 36864
    s_add_u32 m0, s57, 98304
    s_nop 0
    buffer_load_dwordx4 v24, s[20:23], s48 offen offset:0 lds
    buffer_load_dwordx4 v25, s[20:23], s48 offen offset:1024 lds
    buffer_load_dwordx4 v26, s[20:23], s48 offen offset:2048 lds
    buffer_load_dwordx4 v27, s[20:23], s48 offen offset:3072 lds
    s_add_u32 m0, s57, 102400
    s_nop 0
    buffer_load_dwordx4 v24, s[20:23], s49 offen offset:0 lds
    buffer_load_dwordx4 v25, s[20:23], s49 offen offset:1024 lds
    buffer_load_dwordx4 v26, s[20:23], s49 offen offset:2048 lds
    buffer_load_dwordx4 v27, s[20:23], s49 offen offset:3072 lds
    s_waitcnt vmcnt(8)
    s_barrier
    s_add_u32 s48, s91, s33
    s_add_u32 s49, s48, 36864
    s_add_u32 m0, s57, 131072
    s_nop 0
    buffer_load_dwordx4 v24, s[20:23], s48 offen offset:0 lds
    buffer_load_dwordx4 v25, s[20:23], s48 offen offset:1024 lds
    buffer_load_dwordx4 v26, s[20:23], s48 offen offset:2048 lds
    buffer_load_dwordx4 v27, s[20:23], s48 offen offset:3072 lds
    s_add_u32 m0, s57, 135168
    s_nop 0
    buffer_load_dwordx4 v24, s[20:23], s49 offen offset:0 lds
    buffer_load_dwordx4 v25, s[20:23], s49 offen offset:1024 lds
    buffer_load_dwordx4 v26, s[20:23], s49 offen offset:2048 lds
    buffer_load_dwordx4 v27, s[20:23], s49 offen offset:3072 lds
    s_waitcnt vmcnt(8)
    s_barrier
    s_add_u32 s48, s92, s33
    s_add_u32 s49, s48, 36864
    s_add_u32 m0, s57, 65536
    s_nop 0
    buffer_load_dwordx4 v24, s[20:23], s48 offen offset:0 lds
    buffer_load_dwordx4 v25, s[20:23], s48 offen offset:1024 lds
    buffer_load_dwordx4 v26, s[20:23], s48 offen offset:2048 lds
    buffer_load_dwordx4 v27, s[20:23], s48 offen offset:3072 lds
    s_add_u32 m0, s57, 69632
    s_nop 0
    buffer_load_dwordx4 v24, s[20:23], s49 offen offset:0 lds
    buffer_load_dwordx4 v25, s[20:23], s49 offen offset:1024 lds
    buffer_load_dwordx4 v26, s[20:23], s49 offen offset:2048 lds
    buffer_load_dwordx4 v27, s[20:23], s49 offen offset:3072 lds
    s_waitcnt vmcnt(8)
    s_barrier
    s_lshl_b32 s27, s61, 2
    s_add_u32 s27, s27, s26
    s_add_u32 s27, s27, 4096
    s_atomic_add s100, s[40:41], s27
    s_add_u32 s27, s61, 1
    s_and_b32 s27, s27, 7
    s_lshl_b32 s27, s27, 9
    s_add_u32 s27, s27, s26
    s_add_u32 s27, s27, 4
    s_atomic_add s100, s[40:41], s27
    s_add_u32 s27, s61, 2
    s_and_b32 s27, s27, 7
    s_lshl_b32 s27, s27, 9
    s_add_u32 s27, s27, s26
    s_add_u32 s27, s27, 8
    s_atomic_add s100, s[40:41], s27
    s_add_u32 s27, s61, 3
    s_and_b32 s27, s27, 7
    s_lshl_b32 s27, s27, 9
    s_add_u32 s27, s27, s26
    s_add_u32 s27, s27, 12
    s_atomic_add s100, s[40:41], s27
    s_add_u32 s48, s92, s32
    s_add_u32 s49, s48, 36864
    s_add_u32 m0, s57, 98304
    s_nop 0
    buffer_load_dwordx4 v24, s[20:23], s48 offen offset:0 lds
    buffer_load_dwordx4 v25, s[20:23], s48 offen offset:1024 lds
    buffer_load_dwordx4 v26, s[20:23], s48 offen offset:2048 lds
    buffer_load_dwordx4 v27, s[20:23], s48 offen offset:3072 lds
    s_add_u32 m0, s57, 102400
    s_nop 0
    buffer_load_dwordx4 v24, s[20:23], s49 offen offset:0 lds
    buffer_load_dwordx4 v25, s[20:23], s49 offen offset:1024 lds
    buffer_load_dwordx4 v26, s[20:23], s49 offen offset:2048 lds
    buffer_load_dwordx4 v27, s[20:23], s49 offen offset:3072 lds
    s_waitcnt vmcnt(8)
    s_barrier
    s_setprio 3
    s_mov_b32 s4, s40
    s_and_b32 s5, s41, 0xffff
    s_mov_b32 s6, 0x126c000
    s_mov_b32 s7, 0x20000
    s_mov_b32 s8, s52
    s_and_b32 s9, s53, 0xffff
    s_mov_b32 s10, 0x1b0000
    s_mov_b32 s11, 0x20000
    s_lshl_b32 s57, s61, 9
    s_add_u32 s57, s57, s26
    s_load_dwordx8 s[32:39], s[40:41], s57 glc
    s_add_u32 s48, s61, s44
    s_cmp_ge_u32 s48, 9
    s_cselect_b32 s58, 9, 0
    s_sub_u32 s48, s48, s58
    s_lshl_b32 s48, s48, 7
    s_mul_i32 s58, s62, 110592
    s_add_u32 s48, s48, s58
    s_mul_i32 s58, s42, 1152
    s_add_u32 s48, s48, s58
    s_lshl_b32 s58, s46, 5
    s_add_u32 s48, s48, s58
    v_mul_u32_u24 v7, 2304, v2
    v_lshl_add_u32 v7, v3, 3, v7
    v_add_u32 v7, s48, v7
    v_lshlrev_b32 v12, 4, v1
    v_mul_u32_u24 v13, 8, v1
    v_mov_b32 v14, 0x3f80
    v_mov_b32 v15, 0x3f800000
    s_lshl_b32 s51, s42, 4
    s_add_u32 s51, s51, s62
    s_mul_i32 s56, s51, 401408
    s_mul_i32 s58, s46, 1536
    s_add_u32 s56, s56, s58
    s_movk_i32 s49, 0x4800
    s_lshl_b32 s49, s49, 1
    s_lshl_b32 s50, s49, 1
    s_sub_u32 s58, s61, 1
    s_and_b32 s58, s58, 7
    s_mul_i32 s58, s58, 50176
    s_add_u32 s58, s58, s56
    s_add_u32 s85, s58, 6144
    s_sub_u32 s58, s61, 2
    s_and_b32 s58, s58, 7
    s_mul_i32 s58, s58, 50176
    s_add_u32 s58, s58, s56
    s_add_u32 s86, s58, 12288
    s_sub_u32 s58, s61, 3
    s_and_b32 s58, s58, 7
    s_mul_i32 s58, s58, 50176
    s_add_u32 s58, s58, s56
    s_add_u32 s87, s58, 18432
    s_sub_u32 s58, s61, 4
    s_and_b32 s58, s58, 7
    s_mul_i32 s58, s58, 50176
    s_add_u32 s58, s58, s56
    s_add_u32 s88, s58, 24576
    s_sub_u32 s58, s61, 5
    s_and_b32 s58, s58, 7
    s_mul_i32 s58, s58, 50176
    s_add_u32 s58, s58, s56
    s_add_u32 s89, s58, 30720
    s_sub_u32 s58, s61, 6
    s_and_b32 s58, s58, 7
    s_mul_i32 s58, s58, 50176
    s_add_u32 s58, s58, s56
    s_add_u32 s90, s58, 36864
    s_sub_u32 s58, s61, 7
    s_and_b32 s58, s58, 7
    s_mul_i32 s58, s58, 50176
    s_add_u32 s58, s58, s56
    s_add_u32 s91, s58, 43008
    s_mul_i32 s58, s46, 3072
    s_add_u32 s58, s58, 32768
    v_add_u32 v11, s58, v12
    s_waitcnt vmcnt(0)
    s_barrier
    s_mov_b32 s59, 0
HA_P:
    s_waitcnt lgkmcnt(0)
    s_and_b32 s16, s33, s34
    s_and_b32 s16, s16, s35
    s_cbranch_scc1 HA_G
    s_load_dwordx8 s[32:39], s[40:41], s57 glc
    s_add_u32 s59, s59, 1
    s_cmp_lt_u32 s59, 0x40000
    s_cbranch_scc1 HA_P
    s_waitcnt lgkmcnt(0)
HA_G:
    buffer_load_dwordx4 v[40:43], v12, s[4:7], s85 offen sc0 sc1
    buffer_load_dwordx2 v[44:45], v13, s[4:7], s85 offen offset:1024 sc0 sc1
    buffer_load_dwordx4 v[46:49], v12, s[4:7], s86 offen sc0 sc1
    buffer_load_dwordx2 v[50:51], v13, s[4:7], s86 offen offset:1024 sc0 sc1
    buffer_load_dwordx4 v[52:55], v12, s[4:7], s87 offen sc0 sc1
    buffer_load_dwordx2 v[56:57], v13, s[4:7], s87 offen offset:1024 sc0 sc1
    s_mov_b32 s59, 0
HB_P:
    s_waitcnt lgkmcnt(0)
    s_and_b32 s16, s36, s37
    s_cbranch_scc1 HB_G
    s_load_dwordx8 s[32:39], s[40:41], s57 glc
    s_add_u32 s59, s59, 1
    s_cmp_lt_u32 s59, 0x40000
    s_cbranch_scc1 HB_P
    s_waitcnt lgkmcnt(0)
HB_G:
    buffer_load_dwordx4 v[60:63], v12, s[4:7], s88 offen sc0 sc1
    buffer_load_dwordx2 v[64:65], v13, s[4:7], s88 offen offset:1024 sc0 sc1
    buffer_load_dwordx4 v[66:69], v12, s[4:7], s89 offen sc0 sc1
    buffer_load_dwordx2 v[70:71], v13, s[4:7], s89 offen offset:1024 sc0 sc1
    s_and_b32 s16, s38, s39
    s_cselect_b32 s98, 1, 0
    s_cbranch_scc0 HNOC
    buffer_load_dwordx4 v[72:75], v12, s[4:7], s90 offen sc0 sc1
    buffer_load_dwordx2 v[76:77], v13, s[4:7], s90 offen offset:1024 sc0 sc1
    buffer_load_dwordx4 v[78:81], v12, s[4:7], s91 offen sc0 sc1
    buffer_load_dwordx2 v[82:83], v13, s[4:7], s91 offen offset:1024 sc0 sc1
HNOC:
    s_load_dwordx8 s[32:39], s[40:41], s57 glc
    s_waitcnt vmcnt(8)
    v_lshlrev_b32 v16, 16, v40
    v_and_b32 v17, 0xffff0000, v40
    v_lshlrev_b32 v18, 16, v41
    v_and_b32 v19, 0xffff0000, v41
    v_lshlrev_b32 v20, 16, v42
    v_and_b32 v21, 0xffff0000, v42
    v_lshlrev_b32 v22, 16, v43
    v_and_b32 v23, 0xffff0000, v43
    v_lshlrev_b32 v24, 16, v44
    v_and_b32 v25, 0xffff0000, v44
    v_lshlrev_b32 v26, 16, v45
    v_and_b32 v27, 0xffff0000, v45
    s_waitcnt vmcnt(6)
    v_dot2c_f32_bf16 v16, v46, v14
    v_dot2c_f32_bf16 v17, v46, v15
    v_dot2c_f32_bf16 v18, v47, v14
    v_dot2c_f32_bf16 v19, v47, v15
    v_dot2c_f32_bf16 v20, v48, v14
    v_dot2c_f32_bf16 v21, v48, v15
    v_dot2c_f32_bf16 v22, v49, v14
    v_dot2c_f32_bf16 v23, v49, v15
    v_dot2c_f32_bf16 v24, v50, v14
    v_dot2c_f32_bf16 v25, v50, v15
    v_dot2c_f32_bf16 v26, v51, v14
    v_dot2c_f32_bf16 v27, v51, v15
    s_waitcnt vmcnt(4)
    v_dot2c_f32_bf16 v16, v52, v14
    v_dot2c_f32_bf16 v17, v52, v15
    v_dot2c_f32_bf16 v18, v53, v14
    v_dot2c_f32_bf16 v19, v53, v15
    v_dot2c_f32_bf16 v20, v54, v14
    v_dot2c_f32_bf16 v21, v54, v15
    v_dot2c_f32_bf16 v22, v55, v14
    v_dot2c_f32_bf16 v23, v55, v15
    v_dot2c_f32_bf16 v24, v56, v14
    v_dot2c_f32_bf16 v25, v56, v15
    v_dot2c_f32_bf16 v26, v57, v14
    v_dot2c_f32_bf16 v27, v57, v15
    s_waitcnt vmcnt(2)
    v_dot2c_f32_bf16 v16, v60, v14
    v_dot2c_f32_bf16 v17, v60, v15
    v_dot2c_f32_bf16 v18, v61, v14
    v_dot2c_f32_bf16 v19, v61, v15
    v_dot2c_f32_bf16 v20, v62, v14
    v_dot2c_f32_bf16 v21, v62, v15
    v_dot2c_f32_bf16 v22, v63, v14
    v_dot2c_f32_bf16 v23, v63, v15
    v_dot2c_f32_bf16 v24, v64, v14
    v_dot2c_f32_bf16 v25, v64, v15
    v_dot2c_f32_bf16 v26, v65, v14
    v_dot2c_f32_bf16 v27, v65, v15
    s_waitcnt vmcnt(0)
    v_dot2c_f32_bf16 v16, v66, v14
    v_dot2c_f32_bf16 v17, v66, v15
    v_dot2c_f32_bf16 v18, v67, v14
    v_dot2c_f32_bf16 v19, v67, v15
    v_dot2c_f32_bf16 v20, v68, v14
    v_dot2c_f32_bf16 v21, v68, v15
    v_dot2c_f32_bf16 v22, v69, v14
    v_dot2c_f32_bf16 v23, v69, v15
    v_dot2c_f32_bf16 v24, v70, v14
    v_dot2c_f32_bf16 v25, v70, v15
    v_dot2c_f32_bf16 v26, v71, v14
    v_dot2c_f32_bf16 v27, v71, v15
    s_cmp_lg_u32 s98, 0
    s_cbranch_scc1 HOWN
    s_waitcnt lgkmcnt(0)
    s_and_b32 s16, s38, s39
    s_cbranch_scc0 HOWN
    buffer_load_dwordx4 v[72:75], v12, s[4:7], s90 offen sc0 sc1
    buffer_load_dwordx2 v[76:77], v13, s[4:7], s90 offen offset:1024 sc0 sc1
    buffer_load_dwordx4 v[78:81], v12, s[4:7], s91 offen sc0 sc1
    buffer_load_dwordx2 v[82:83], v13, s[4:7], s91 offen offset:1024 sc0 sc1
    s_mov_b32 s98, 1
HOWN:
    s_mov_b32 s59, 0
HL_P:
    ds_read_b32 v38, v37
    s_waitcnt lgkmcnt(0)
    v_readfirstlane_b32 s58, v38
    s_add_u32 s59, s59, 1
    s_cmp_lg_u32 s58, 0
    s_cbranch_scc1 HL_G
    s_sleep 1
    s_cmp_lt_u32 s59, 0x400000
    s_cbranch_scc1 HL_P
HL_G:
    ds_read_b128 v[40:43], v11 offset:0
    ds_read_b128 v[44:47], v11 offset:1024
    ds_read_b128 v[48:51], v11 offset:2048
    s_waitcnt lgkmcnt(0)
    v_add_f32 v16, v16, v40
    v_add_f32 v17, v17, v41
    v_add_f32 v18, v18, v42
    v_add_f32 v19, v19, v43
    v_add_f32 v20, v20, v44
    v_add_f32 v21, v21, v45
    v_add_f32 v22, v22, v46
    v_add_f32 v23, v23, v47
    v_add_f32 v24, v24, v48
    v_add_f32 v25, v25, v49
    v_add_f32 v26, v26, v50
    v_add_f32 v27, v27, v51
    s_cmp_lg_u32 s98, 0
    s_cbranch_scc1 HSUMC
    s_mov_b32 s59, 0
HC2_P:
    s_waitcnt lgkmcnt(0)
    s_and_b32 s16, s38, s39
    s_cbranch_scc1 HC2_G
    s_load_dwordx8 s[32:39], s[40:41], s57 glc
    s_add_u32 s59, s59, 1
    s_cmp_lt_u32 s59, 0x40000
    s_cbranch_scc1 HC2_P
    s_waitcnt lgkmcnt(0)
HC2_G:
    buffer_load_dwordx4 v[72:75], v12, s[4:7], s90 offen sc0 sc1
    buffer_load_dwordx2 v[76:77], v13, s[4:7], s90 offen offset:1024 sc0 sc1
    buffer_load_dwordx4 v[78:81], v12, s[4:7], s91 offen sc0 sc1
    buffer_load_dwordx2 v[82:83], v13, s[4:7], s91 offen offset:1024 sc0 sc1
HSUMC:
    s_waitcnt vmcnt(2)
    v_dot2c_f32_bf16 v16, v72, v14
    v_dot2c_f32_bf16 v17, v72, v15
    v_dot2c_f32_bf16 v18, v73, v14
    v_dot2c_f32_bf16 v19, v73, v15
    v_dot2c_f32_bf16 v20, v74, v14
    v_dot2c_f32_bf16 v21, v74, v15
    v_dot2c_f32_bf16 v22, v75, v14
    v_dot2c_f32_bf16 v23, v75, v15
    v_dot2c_f32_bf16 v24, v76, v14
    v_dot2c_f32_bf16 v25, v76, v15
    v_dot2c_f32_bf16 v26, v77, v14
    v_dot2c_f32_bf16 v27, v77, v15
    s_waitcnt vmcnt(0)
    v_dot2c_f32_bf16 v16, v78, v14
    v_dot2c_f32_bf16 v17, v78, v15
    v_dot2c_f32_bf16 v18, v79, v14
    v_dot2c_f32_bf16 v19, v79, v15
    v_dot2c_f32_bf16 v20, v80, v14
    v_dot2c_f32_bf16 v21, v80, v15
    v_dot2c_f32_bf16 v22, v81, v14
    v_dot2c_f32_bf16 v23, v81, v15
    v_dot2c_f32_bf16 v24, v82, v14
    v_dot2c_f32_bf16 v25, v82, v15
    v_dot2c_f32_bf16 v26, v83, v14
    v_dot2c_f32_bf16 v27, v83, v15
    s_nop 2
    v_cvt_pk_bf16_f32 v16, v16, v17
    v_cvt_pk_bf16_f32 v17, v18, v19
    v_cvt_pk_bf16_f32 v18, v20, v21
    v_cvt_pk_bf16_f32 v19, v22, v23
    v_cvt_pk_bf16_f32 v20, v24, v25
    v_cvt_pk_bf16_f32 v21, v26, v27
    buffer_store_dwordx2 v[16:17], v7, s[8:11], 0 offen
    buffer_store_dwordx2 v[18:19], v7, s[8:11], s49 offen
    buffer_store_dwordx2 v[20:21], v7, s[8:11], s50 offen
M_END:
    s_endpgm
COMPUTE:
    s_lshr_b32 s48, s46, 1
    s_and_b32 s49, s46, 1
    s_and_b32 s50, s43, 1
    s_xor_b32 s57, s48, s50
    s_lshl_b32 s50, s42, 4
    s_add_u32 s50, s50, s62
    s_lshr_b32 s56, s43, 1
    s_mul_i32 s51, s50, 4608
    s_lshl_b32 s58, s46, 7
    s_add_u32 s51, s51, s58
    s_add_u32 s61, s51, 19136512
    v_add_u32 v4, s56, v1
    v_and_b32 v4, 7, v4
    v_lshlrev_b32 v4, 9, v4
    v_lshl_add_u32 v4, v1, 2, v4
    s_lshl_b32 s58, s56, 2
    s_add_u32 s58, s58, 4096
    v_mov_b32 v5, s58
    v_cmp_eq_u32 vcc, 0, v1
    s_nop 1
    v_cndmask_b32 v4, v4, v5, vcc
    v_add_u32 v4, s61, v4
    v_mov_b32 v5, 0x7ffffff0
    v_cmp_gt_u32 vcc, 8, v1
    s_nop 1
    v_cndmask_b32 v31, v5, v4, vcc
    s_lshl_b32 s51, s63, 7
    s_add_u32 s51, s51, 19283968
    s_cmp_eq_u32 s46, 0
    s_cselect_b32 s51, s51, 0x7ffffff0
    v_mov_b32 v4, s51
    v_cmp_eq_u32 vcc, 8, v1
    s_nop 1
    v_cndmask_b32 v6, v31, v4, vcc
    v_mov_b32 v7, 0
    s_waitcnt lgkmcnt(0)
    s_mov_b32 s4, s40
    s_and_b32 s5, s41, 0xffff
    s_mov_b32 s6, 0x126c000
    s_mov_b32 s7, 0x20000
    buffer_store_dword v7, v6, s[4:7], 0 offen sc0 sc1
    s_mov_b32 s8, s52
    s_and_b32 s9, s53, 0xffff
    s_mov_b32 s10, 0x1b0000
    s_mov_b32 s11, 0x20000
    s_lshl_b32 s50, s50, 3
    s_add_u32 s50, s50, s56
    s_mul_i32 s58, s50, 50176
    s_mul_i32 s50, s46, 1536
    s_add_u32 s58, s58, s50
    v_mul_u32_u24 v4, 8, v1
    v_add_u32 v29, s58, v4
    v_lshlrev_b32 v4, 4, v1
    v_add_u32 v30, s58, v4
    s_mul_i32 s50, s49, 12288
    s_mul_i32 s51, s63, 24576
    s_add_u32 s51, s51, 12845056
    s_add_u32 s51, s51, s50
    s_cmp_eq_u32 s57, 1
    s_cselect_b32 s51, s51, 0x7fffeff0
    v_add_u32 v28, s50, v4
    v_add_u32 v32, s51, v4
    v_mov_b32 v33, v4
    s_lshl_b32 s50, s49, 13
    s_add_u32 s50, s50, 98304
    v_lshlrev_b32 v4, 11, v3
    v_add_u32 v4, s50, v4
    v_lshrrev_b32 v6, 2, v2
    v_lshl_add_u32 v4, v6, 8, v4
    v_and_b32 v5, 1, v3
    v_lshl_add_u32 v5, v5, 2, v6
    v_and_b32 v6, 3, v2
    v_lshl_add_u32 v4, v6, 3, v4
    v_xor_b32 v6, 0, v5
    v_lshl_add_u32 v8, v6, 5, v4
    v_xor_b32 v6, 1, v5
    v_lshl_add_u32 v9, v6, 5, v4
    v_xor_b32 v6, 2, v5
    v_lshl_add_u32 v10, v6, 5, v4
    v_xor_b32 v6, 3, v5
    v_lshl_add_u32 v11, v6, 5, v4
    v_xor_b32 v6, 4, v5
    v_lshl_add_u32 v12, v6, 5, v4
    v_xor_b32 v6, 5, v5
    v_lshl_add_u32 v13, v6, 5, v4
    v_xor_b32 v6, 6, v5
    v_lshl_add_u32 v14, v6, 5, v4
    v_xor_b32 v6, 7, v5
    v_lshl_add_u32 v15, v6, 5, v4
    s_mul_i32 s50, s48, 6144
    s_add_u32 s50, s50, 49152
    v_lshrrev_b32 v4, 1, v2
    v_xor_b32 v4, v4, v3
    v_lshlrev_b32 v4, 4, v4
    v_lshlrev_b32 v5, 7, v2
    v_add_u32 v5, s50, v5
    v_add_u32 v24, v5, v4
    v_xor_b32 v4, 64, v4
    v_add_u32 v25, v5, v4
    s_lshl_b32 s50, s46, 12
    v_lshrrev_b32 v4, 1, v3
    v_xor_b32 v4, v4, v2
    v_lshlrev_b32 v4, 4, v4
    v_lshl_add_u32 v4, v2, 8, v4
    v_and_b32 v5, 1, v3
    v_lshl_add_u32 v4, v5, 3, v4
    v_add_u32 v26, s50, v4
    v_xor_b32 v16, 0, v26
    v_xor_b32 v17, 32, v26
    v_xor_b32 v18, 64, v26
    v_xor_b32 v19, 96, v26
    v_xor_b32 v20, 128, v26
    v_xor_b32 v21, 160, v26
    v_xor_b32 v22, 192, v26
    v_xor_b32 v23, 224, v26
    s_add_u32 s50, s50, 98304
    v_lshrrev_b32 v4, 2, v1
    v_and_b32 v5, 7, v4
    v_lshlrev_b32 v5, 5, v5
    v_lshl_add_u32 v4, v4, 8, v5
    v_and_b32 v5, 3, v2
    v_lshl_add_u32 v4, v5, 3, v4
    v_add_u32 v27, s50, v4
    v_lshrrev_b32 v4, 2, v1
    v_lshlrev_b32 v5, 7, v4
    v_and_b32 v6, 3, v2
    v_lshl_add_u32 v5, v6, 3, v5
    v_lshrrev_b32 v4, 1, v4
    v_and_b32 v4, 3, v4
    v_xor_b32 v4, s46, v4
    v_lshl_add_u32 v4, v4, 5, v5
    v_add_u32 v4, 65536, v4
    v_mov_b32 v5, v30
    v_mov_b32 v6, v31
    v_mov_b32 v3, v32
    v_mov_b32 v2, v33
    v_mov_b32 v7, 1
    v_mov_b32 v1, v29
    s_mul_i32 s24, s46, 3072
    s_lshl_b32 s25, s46, 11
    s_add_u32 s25, s25, 49152
    s_movk_i32 s27, 4096
    s_movk_i32 s28, 8192
    s_mov_b32 s60, 0x3e0293ee
    s_setprio 2
    s_barrier
    ds_read_b128 v[136:139], v24 offset:0
    ds_read_b128 v[140:143], v24 offset:2048
    ds_read_b128 v[144:147], v24 offset:4096
    ds_read_b64_tr_b16 v[148:149], v8 offset:0
    ds_read_b64_tr_b16 v[150:151], v8 offset:1024
    ds_read_b64_tr_b16 v[152:153], v9 offset:0
    ds_read_b64_tr_b16 v[154:155], v9 offset:1024
    ds_read_b64_tr_b16 v[156:157], v10 offset:0
    ds_read_b64_tr_b16 v[158:159], v10 offset:1024
    ds_read_b64_tr_b16 v[160:161], v11 offset:0
    ds_read_b64_tr_b16 v[162:163], v11 offset:1024
    ds_read_b64_tr_b16 v[164:165], v12 offset:0
    ds_read_b64_tr_b16 v[166:167], v12 offset:1024
    ds_read_b64_tr_b16 v[168:169], v13 offset:0
    ds_read_b64_tr_b16 v[170:171], v13 offset:1024
    ds_read_b64_tr_b16 v[172:173], v14 offset:0
    ds_read_b64_tr_b16 v[174:175], v14 offset:1024
    ds_read_b64_tr_b16 v[176:177], v15 offset:0
    ds_read_b64_tr_b16 v[178:179], v15 offset:1024
    s_waitcnt lgkmcnt(0)
    s_barrier
    v_mfma_f32_16x16x32_bf16 v[40:43], v[148:151], v[136:139], 0
    ds_read_b128 v[180:183], v25 offset:0
    v_mfma_f32_16x16x32_bf16 v[44:47], v[148:151], v[140:143], 0
    ds_read_b128 v[184:187], v25 offset:2048
    v_mfma_f32_16x16x32_bf16 v[48:51], v[148:151], v[144:147], 0
    ds_read_b128 v[188:191], v25 offset:4096
    v_mfma_f32_16x16x32_bf16 v[52:55], v[152:155], v[136:139], 0
    ds_read_b64_tr_b16 v[192:193], v8 offset:16384
    v_mfma_f32_16x16x32_bf16 v[56:59], v[152:155], v[140:143], 0
    ds_read_b64_tr_b16 v[194:195], v8 offset:17408
    v_mfma_f32_16x16x32_bf16 v[60:63], v[152:155], v[144:147], 0
    ds_read_b64_tr_b16 v[196:197], v9 offset:16384
    v_mfma_f32_16x16x32_bf16 v[64:67], v[156:159], v[136:139], 0
    ds_read_b64_tr_b16 v[198:199], v9 offset:17408
    v_mfma_f32_16x16x32_bf16 v[68:71], v[156:159], v[140:143], 0
    ds_read_b64_tr_b16 v[200:201], v10 offset:16384
    v_mfma_f32_16x16x32_bf16 v[72:75], v[156:159], v[144:147], 0
    ds_read_b64_tr_b16 v[202:203], v10 offset:17408
    v_mfma_f32_16x16x32_bf16 v[76:79], v[160:163], v[136:139], 0
    ds_read_b64_tr_b16 v[204:205], v11 offset:16384
    v_mfma_f32_16x16x32_bf16 v[80:83], v[160:163], v[140:143], 0
    ds_read_b64_tr_b16 v[206:207], v11 offset:17408
    v_mfma_f32_16x16x32_bf16 v[84:87], v[160:163], v[144:147], 0
    ds_read_b64_tr_b16 v[208:209], v12 offset:16384
    v_mfma_f32_16x16x32_bf16 v[88:91], v[164:167], v[136:139], 0
    ds_read_b64_tr_b16 v[210:211], v12 offset:17408
    v_mfma_f32_16x16x32_bf16 v[92:95], v[164:167], v[140:143], 0
    ds_read_b64_tr_b16 v[212:213], v13 offset:16384
    v_mfma_f32_16x16x32_bf16 v[96:99], v[164:167], v[144:147], 0
    ds_read_b64_tr_b16 v[214:215], v13 offset:17408
    v_mfma_f32_16x16x32_bf16 v[100:103], v[168:171], v[136:139], 0
    ds_read_b64_tr_b16 v[216:217], v14 offset:16384
    v_mfma_f32_16x16x32_bf16 v[104:107], v[168:171], v[140:143], 0
    ds_read_b64_tr_b16 v[218:219], v14 offset:17408
    v_mfma_f32_16x16x32_bf16 v[108:111], v[168:171], v[144:147], 0
    ds_read_b64_tr_b16 v[220:221], v15 offset:16384
    v_mfma_f32_16x16x32_bf16 v[112:115], v[172:175], v[136:139], 0
    ds_read_b64_tr_b16 v[222:223], v15 offset:17408
    v_mfma_f32_16x16x32_bf16 v[116:119], v[172:175], v[140:143], 0
    v_mfma_f32_16x16x32_bf16 v[120:123], v[172:175], v[144:147], 0
    v_mfma_f32_16x16x32_bf16 v[124:127], v[176:179], v[136:139], 0
    v_mfma_f32_16x16x32_bf16 v[128:131], v[176:179], v[140:143], 0
    v_mfma_f32_16x16x32_bf16 v[132:135], v[176:179], v[144:147], 0
    s_waitcnt lgkmcnt(0)
    s_barrier
    v_mfma_f32_16x16x32_bf16 v[40:43], v[192:195], v[180:183], v[40:43]
    ds_read_b128 v[136:139], v24 offset:12288
    v_mfma_f32_16x16x32_bf16 v[44:47], v[192:195], v[184:187], v[44:47]
    ds_read_b128 v[140:143], v24 offset:14336
    v_mfma_f32_16x16x32_bf16 v[48:51], v[192:195], v[188:191], v[48:51]
    ds_read_b128 v[144:147], v24 offset:16384
    v_mfma_f32_16x16x32_bf16 v[52:55], v[196:199], v[180:183], v[52:55]
    ds_read_b64_tr_b16 v[148:149], v8 offset:32768
    v_mfma_f32_16x16x32_bf16 v[56:59], v[196:199], v[184:187], v[56:59]
    ds_read_b64_tr_b16 v[150:151], v8 offset:33792
    v_mfma_f32_16x16x32_bf16 v[60:63], v[196:199], v[188:191], v[60:63]
    ds_read_b64_tr_b16 v[152:153], v9 offset:32768
    v_mfma_f32_16x16x32_bf16 v[64:67], v[200:203], v[180:183], v[64:67]
    ds_read_b64_tr_b16 v[154:155], v9 offset:33792
    v_mfma_f32_16x16x32_bf16 v[68:71], v[200:203], v[184:187], v[68:71]
    ds_read_b64_tr_b16 v[156:157], v10 offset:32768
    v_mfma_f32_16x16x32_bf16 v[72:75], v[200:203], v[188:191], v[72:75]
    ds_read_b64_tr_b16 v[158:159], v10 offset:33792
    v_mfma_f32_16x16x32_bf16 v[76:79], v[204:207], v[180:183], v[76:79]
    ds_read_b64_tr_b16 v[160:161], v11 offset:32768
    v_mfma_f32_16x16x32_bf16 v[80:83], v[204:207], v[184:187], v[80:83]
    ds_read_b64_tr_b16 v[162:163], v11 offset:33792
    v_mfma_f32_16x16x32_bf16 v[84:87], v[204:207], v[188:191], v[84:87]
    ds_read_b64_tr_b16 v[164:165], v12 offset:32768
    v_mfma_f32_16x16x32_bf16 v[88:91], v[208:211], v[180:183], v[88:91]
    ds_read_b64_tr_b16 v[166:167], v12 offset:33792
    v_mfma_f32_16x16x32_bf16 v[92:95], v[208:211], v[184:187], v[92:95]
    ds_read_b64_tr_b16 v[168:169], v13 offset:32768
    v_mfma_f32_16x16x32_bf16 v[96:99], v[208:211], v[188:191], v[96:99]
    ds_read_b64_tr_b16 v[170:171], v13 offset:33792
    v_mfma_f32_16x16x32_bf16 v[100:103], v[212:215], v[180:183], v[100:103]
    ds_read_b64_tr_b16 v[172:173], v14 offset:32768
    v_mfma_f32_16x16x32_bf16 v[104:107], v[212:215], v[184:187], v[104:107]
    ds_read_b64_tr_b16 v[174:175], v14 offset:33792
    v_mfma_f32_16x16x32_bf16 v[108:111], v[212:215], v[188:191], v[108:111]
    ds_read_b64_tr_b16 v[176:177], v15 offset:32768
    v_mfma_f32_16x16x32_bf16 v[112:115], v[216:219], v[180:183], v[112:115]
    ds_read_b64_tr_b16 v[178:179], v15 offset:33792
    v_mfma_f32_16x16x32_bf16 v[116:119], v[216:219], v[184:187], v[116:119]
    v_mfma_f32_16x16x32_bf16 v[120:123], v[216:219], v[188:191], v[120:123]
    v_mfma_f32_16x16x32_bf16 v[124:127], v[220:223], v[180:183], v[124:127]
    v_mfma_f32_16x16x32_bf16 v[128:131], v[220:223], v[184:187], v[128:131]
    v_mfma_f32_16x16x32_bf16 v[132:135], v[220:223], v[188:191], v[132:135]
    s_waitcnt lgkmcnt(0)
    s_barrier
    v_mfma_f32_16x16x32_bf16 v[40:43], v[148:151], v[136:139], v[40:43]
    ds_read_b128 v[180:183], v25 offset:12288
    v_mfma_f32_16x16x32_bf16 v[44:47], v[148:151], v[140:143], v[44:47]
    ds_read_b128 v[184:187], v25 offset:14336
    v_mfma_f32_16x16x32_bf16 v[48:51], v[148:151], v[144:147], v[48:51]
    ds_read_b128 v[188:191], v25 offset:16384
    v_mfma_f32_16x16x32_bf16 v[52:55], v[152:155], v[136:139], v[52:55]
    ds_read_b64_tr_b16 v[192:193], v8 offset:49152
    v_mfma_f32_16x16x32_bf16 v[56:59], v[152:155], v[140:143], v[56:59]
    ds_read_b64_tr_b16 v[194:195], v8 offset:50176
    v_mfma_f32_16x16x32_bf16 v[60:63], v[152:155], v[144:147], v[60:63]
    ds_read_b64_tr_b16 v[196:197], v9 offset:49152
    v_mfma_f32_16x16x32_bf16 v[64:67], v[156:159], v[136:139], v[64:67]
    ds_read_b64_tr_b16 v[198:199], v9 offset:50176
    v_mfma_f32_16x16x32_bf16 v[68:71], v[156:159], v[140:143], v[68:71]
    ds_read_b64_tr_b16 v[200:201], v10 offset:49152
    v_mfma_f32_16x16x32_bf16 v[72:75], v[156:159], v[144:147], v[72:75]
    ds_read_b64_tr_b16 v[202:203], v10 offset:50176
    v_mfma_f32_16x16x32_bf16 v[76:79], v[160:163], v[136:139], v[76:79]
    ds_read_b64_tr_b16 v[204:205], v11 offset:49152
    v_mfma_f32_16x16x32_bf16 v[80:83], v[160:163], v[140:143], v[80:83]
    ds_read_b64_tr_b16 v[206:207], v11 offset:50176
    v_mfma_f32_16x16x32_bf16 v[84:87], v[160:163], v[144:147], v[84:87]
    ds_read_b64_tr_b16 v[208:209], v12 offset:49152
    v_mfma_f32_16x16x32_bf16 v[88:91], v[164:167], v[136:139], v[88:91]
    ds_read_b64_tr_b16 v[210:211], v12 offset:50176
    v_mfma_f32_16x16x32_bf16 v[92:95], v[164:167], v[140:143], v[92:95]
    ds_read_b64_tr_b16 v[212:213], v13 offset:49152
    v_mfma_f32_16x16x32_bf16 v[96:99], v[164:167], v[144:147], v[96:99]
    ds_read_b64_tr_b16 v[214:215], v13 offset:50176
    v_mfma_f32_16x16x32_bf16 v[100:103], v[168:171], v[136:139], v[100:103]
    ds_read_b64_tr_b16 v[216:217], v14 offset:49152
    v_mfma_f32_16x16x32_bf16 v[104:107], v[168:171], v[140:143], v[104:107]
    ds_read_b64_tr_b16 v[218:219], v14 offset:50176
    v_mfma_f32_16x16x32_bf16 v[108:111], v[168:171], v[144:147], v[108:111]
    ds_read_b64_tr_b16 v[220:221], v15 offset:49152
    v_mfma_f32_16x16x32_bf16 v[112:115], v[172:175], v[136:139], v[112:115]
    ds_read_b64_tr_b16 v[222:223], v15 offset:50176
    v_mfma_f32_16x16x32_bf16 v[116:119], v[172:175], v[140:143], v[116:119]
    v_mfma_f32_16x16x32_bf16 v[120:123], v[172:175], v[144:147], v[120:123]
    v_mfma_f32_16x16x32_bf16 v[124:127], v[176:179], v[136:139], v[124:127]
    v_mfma_f32_16x16x32_bf16 v[128:131], v[176:179], v[140:143], v[128:131]
    v_mfma_f32_16x16x32_bf16 v[132:135], v[176:179], v[144:147], v[132:135]
    s_waitcnt vmcnt(0) lgkmcnt(0)
    s_barrier
    v_mfma_f32_16x16x32_bf16 v[40:43], v[192:195], v[180:183], v[40:43]
    ds_read_b128 v[136:139], v24 offset:24576
    v_mfma_f32_16x16x32_bf16 v[44:47], v[192:195], v[184:187], v[44:47]
    ds_read_b128 v[140:143], v24 offset:26624
    v_mfma_f32_16x16x32_bf16 v[48:51], v[192:195], v[188:191], v[48:51]
    ds_read_b128 v[144:147], v24 offset:28672
    v_mfma_f32_16x16x32_bf16 v[52:55], v[196:199], v[180:183], v[52:55]
    ds_read_b64_tr_b16 v[148:149], v8 offset:0
    v_mfma_f32_16x16x32_bf16 v[56:59], v[196:199], v[184:187], v[56:59]
    ds_read_b64_tr_b16 v[150:151], v8 offset:1024
    v_mfma_f32_16x16x32_bf16 v[60:63], v[196:199], v[188:191], v[60:63]
    ds_read_b64_tr_b16 v[152:153], v9 offset:0
    v_mfma_f32_16x16x32_bf16 v[64:67], v[200:203], v[180:183], v[64:67]
    ds_read_b64_tr_b16 v[154:155], v9 offset:1024
    v_mfma_f32_16x16x32_bf16 v[68:71], v[200:203], v[184:187], v[68:71]
    ds_read_b64_tr_b16 v[156:157], v10 offset:0
    v_mfma_f32_16x16x32_bf16 v[72:75], v[200:203], v[188:191], v[72:75]
    ds_read_b64_tr_b16 v[158:159], v10 offset:1024
    v_mfma_f32_16x16x32_bf16 v[76:79], v[204:207], v[180:183], v[76:79]
    ds_read_b64_tr_b16 v[160:161], v11 offset:0
    v_mfma_f32_16x16x32_bf16 v[80:83], v[204:207], v[184:187], v[80:83]
    ds_read_b64_tr_b16 v[162:163], v11 offset:1024
    v_mfma_f32_16x16x32_bf16 v[84:87], v[204:207], v[188:191], v[84:87]
    ds_read_b64_tr_b16 v[164:165], v12 offset:0
    v_mfma_f32_16x16x32_bf16 v[88:91], v[208:211], v[180:183], v[88:91]
    ds_read_b64_tr_b16 v[166:167], v12 offset:1024
    v_mfma_f32_16x16x32_bf16 v[92:95], v[208:211], v[184:187], v[92:95]
    ds_read_b64_tr_b16 v[168:169], v13 offset:0
    v_mfma_f32_16x16x32_bf16 v[96:99], v[208:211], v[188:191], v[96:99]
    ds_read_b64_tr_b16 v[170:171], v13 offset:1024
    v_mfma_f32_16x16x32_bf16 v[100:103], v[212:215], v[180:183], v[100:103]
    ds_read_b64_tr_b16 v[172:173], v14 offset:0
    v_mfma_f32_16x16x32_bf16 v[104:107], v[212:215], v[184:187], v[104:107]
    ds_read_b64_tr_b16 v[174:175], v14 offset:1024
    v_mfma_f32_16x16x32_bf16 v[108:111], v[212:215], v[188:191], v[108:111]
    ds_read_b64_tr_b16 v[176:177], v15 offset:0
    v_mfma_f32_16x16x32_bf16 v[112:115], v[216:219], v[180:183], v[112:115]
    ds_read_b64_tr_b16 v[178:179], v15 offset:1024
    v_mfma_f32_16x16x32_bf16 v[116:119], v[216:219], v[184:187], v[116:119]
    v_mfma_f32_16x16x32_bf16 v[120:123], v[216:219], v[188:191], v[120:123]
    v_mfma_f32_16x16x32_bf16 v[124:127], v[220:223], v[180:183], v[124:127]
    v_mfma_f32_16x16x32_bf16 v[128:131], v[220:223], v[184:187], v[128:131]
    v_mfma_f32_16x16x32_bf16 v[132:135], v[220:223], v[188:191], v[132:135]
    s_waitcnt lgkmcnt(0)
    s_barrier
    v_mfma_f32_16x16x32_bf16 v[40:43], v[148:151], v[136:139], v[40:43]
    ds_read_b128 v[180:183], v25 offset:24576
    v_mfma_f32_16x16x32_bf16 v[44:47], v[148:151], v[140:143], v[44:47]
    ds_read_b128 v[184:187], v25 offset:26624
    v_mfma_f32_16x16x32_bf16 v[48:51], v[148:151], v[144:147], v[48:51]
    ds_read_b128 v[188:191], v25 offset:28672
    v_mfma_f32_16x16x32_bf16 v[52:55], v[152:155], v[136:139], v[52:55]
    ds_read_b64_tr_b16 v[192:193], v8 offset:16384
    v_mfma_f32_16x16x32_bf16 v[56:59], v[152:155], v[140:143], v[56:59]
    ds_read_b64_tr_b16 v[194:195], v8 offset:17408
    v_mfma_f32_16x16x32_bf16 v[60:63], v[152:155], v[144:147], v[60:63]
    ds_read_b64_tr_b16 v[196:197], v9 offset:16384
    v_mfma_f32_16x16x32_bf16 v[64:67], v[156:159], v[136:139], v[64:67]
    ds_read_b64_tr_b16 v[198:199], v9 offset:17408
    v_mfma_f32_16x16x32_bf16 v[68:71], v[156:159], v[140:143], v[68:71]
    ds_read_b64_tr_b16 v[200:201], v10 offset:16384
    v_mfma_f32_16x16x32_bf16 v[72:75], v[156:159], v[144:147], v[72:75]
    ds_read_b64_tr_b16 v[202:203], v10 offset:17408
    v_mfma_f32_16x16x32_bf16 v[76:79], v[160:163], v[136:139], v[76:79]
    ds_read_b64_tr_b16 v[204:205], v11 offset:16384
    v_mfma_f32_16x16x32_bf16 v[80:83], v[160:163], v[140:143], v[80:83]
    ds_read_b64_tr_b16 v[206:207], v11 offset:17408
    v_mfma_f32_16x16x32_bf16 v[84:87], v[160:163], v[144:147], v[84:87]
    ds_read_b64_tr_b16 v[208:209], v12 offset:16384
    v_mfma_f32_16x16x32_bf16 v[88:91], v[164:167], v[136:139], v[88:91]
    ds_read_b64_tr_b16 v[210:211], v12 offset:17408
    v_mfma_f32_16x16x32_bf16 v[92:95], v[164:167], v[140:143], v[92:95]
    ds_read_b64_tr_b16 v[212:213], v13 offset:16384
    v_mfma_f32_16x16x32_bf16 v[96:99], v[164:167], v[144:147], v[96:99]
    ds_read_b64_tr_b16 v[214:215], v13 offset:17408
    v_mfma_f32_16x16x32_bf16 v[100:103], v[168:171], v[136:139], v[100:103]
    ds_read_b64_tr_b16 v[216:217], v14 offset:16384
    v_mfma_f32_16x16x32_bf16 v[104:107], v[168:171], v[140:143], v[104:107]
    ds_read_b64_tr_b16 v[218:219], v14 offset:17408
    v_mfma_f32_16x16x32_bf16 v[108:111], v[168:171], v[144:147], v[108:111]
    ds_read_b64_tr_b16 v[220:221], v15 offset:16384
    v_mfma_f32_16x16x32_bf16 v[112:115], v[172:175], v[136:139], v[112:115]
    ds_read_b64_tr_b16 v[222:223], v15 offset:17408
    v_mfma_f32_16x16x32_bf16 v[116:119], v[172:175], v[140:143], v[116:119]
    v_mfma_f32_16x16x32_bf16 v[120:123], v[172:175], v[144:147], v[120:123]
    v_mfma_f32_16x16x32_bf16 v[124:127], v[176:179], v[136:139], v[124:127]
    v_mfma_f32_16x16x32_bf16 v[128:131], v[176:179], v[140:143], v[128:131]
    v_mfma_f32_16x16x32_bf16 v[132:135], v[176:179], v[144:147], v[132:135]
    s_waitcnt lgkmcnt(0)
    s_barrier
    v_mfma_f32_16x16x32_bf16 v[40:43], v[192:195], v[180:183], v[40:43]
    ds_read_b128 v[136:139], v24 offset:0
    v_mfma_f32_16x16x32_bf16 v[44:47], v[192:195], v[184:187], v[44:47]
    ds_read_b128 v[140:143], v24 offset:2048
    v_mfma_f32_16x16x32_bf16 v[48:51], v[192:195], v[188:191], v[48:51]
    ds_read_b128 v[144:147], v24 offset:4096
    v_mfma_f32_16x16x32_bf16 v[52:55], v[196:199], v[180:183], v[52:55]
    ds_read_b64_tr_b16 v[148:149], v8 offset:32768
    v_mfma_f32_16x16x32_bf16 v[56:59], v[196:199], v[184:187], v[56:59]
    ds_read_b64_tr_b16 v[150:151], v8 offset:33792
    v_mfma_f32_16x16x32_bf16 v[60:63], v[196:199], v[188:191], v[60:63]
    ds_read_b64_tr_b16 v[152:153], v9 offset:32768
    v_mfma_f32_16x16x32_bf16 v[64:67], v[200:203], v[180:183], v[64:67]
    ds_read_b64_tr_b16 v[154:155], v9 offset:33792
    v_mfma_f32_16x16x32_bf16 v[68:71], v[200:203], v[184:187], v[68:71]
    ds_read_b64_tr_b16 v[156:157], v10 offset:32768
    v_mfma_f32_16x16x32_bf16 v[72:75], v[200:203], v[188:191], v[72:75]
    ds_read_b64_tr_b16 v[158:159], v10 offset:33792
    v_mfma_f32_16x16x32_bf16 v[76:79], v[204:207], v[180:183], v[76:79]
    ds_read_b64_tr_b16 v[160:161], v11 offset:32768
    v_mfma_f32_16x16x32_bf16 v[80:83], v[204:207], v[184:187], v[80:83]
    ds_read_b64_tr_b16 v[162:163], v11 offset:33792
    v_mfma_f32_16x16x32_bf16 v[84:87], v[204:207], v[188:191], v[84:87]
    ds_read_b64_tr_b16 v[164:165], v12 offset:32768
    v_mfma_f32_16x16x32_bf16 v[88:91], v[208:211], v[180:183], v[88:91]
    ds_read_b64_tr_b16 v[166:167], v12 offset:33792
    v_mfma_f32_16x16x32_bf16 v[92:95], v[208:211], v[184:187], v[92:95]
    ds_read_b64_tr_b16 v[168:169], v13 offset:32768
    v_mfma_f32_16x16x32_bf16 v[96:99], v[208:211], v[188:191], v[96:99]
    ds_read_b64_tr_b16 v[170:171], v13 offset:33792
    v_mfma_f32_16x16x32_bf16 v[100:103], v[212:215], v[180:183], v[100:103]
    ds_read_b64_tr_b16 v[172:173], v14 offset:32768
    v_mfma_f32_16x16x32_bf16 v[104:107], v[212:215], v[184:187], v[104:107]
    ds_read_b64_tr_b16 v[174:175], v14 offset:33792
    v_mfma_f32_16x16x32_bf16 v[108:111], v[212:215], v[188:191], v[108:111]
    ds_read_b64_tr_b16 v[176:177], v15 offset:32768
    v_mfma_f32_16x16x32_bf16 v[112:115], v[216:219], v[180:183], v[112:115]
    ds_read_b64_tr_b16 v[178:179], v15 offset:33792
    v_mfma_f32_16x16x32_bf16 v[116:119], v[216:219], v[184:187], v[116:119]
    v_mfma_f32_16x16x32_bf16 v[120:123], v[216:219], v[188:191], v[120:123]
    v_mfma_f32_16x16x32_bf16 v[124:127], v[220:223], v[180:183], v[124:127]
    v_mfma_f32_16x16x32_bf16 v[128:131], v[220:223], v[184:187], v[128:131]
    v_mfma_f32_16x16x32_bf16 v[132:135], v[220:223], v[188:191], v[132:135]
    s_waitcnt lgkmcnt(0)
    s_barrier
    v_mfma_f32_16x16x32_bf16 v[40:43], v[148:151], v[136:139], v[40:43]
    ds_read_b128 v[180:183], v25 offset:0
    v_mfma_f32_16x16x32_bf16 v[44:47], v[148:151], v[140:143], v[44:47]
    ds_read_b128 v[184:187], v25 offset:2048
    v_mfma_f32_16x16x32_bf16 v[48:51], v[148:151], v[144:147], v[48:51]
    ds_read_b128 v[188:191], v25 offset:4096
    v_mfma_f32_16x16x32_bf16 v[52:55], v[152:155], v[136:139], v[52:55]
    ds_read_b64_tr_b16 v[192:193], v8 offset:49152
    v_mfma_f32_16x16x32_bf16 v[56:59], v[152:155], v[140:143], v[56:59]
    ds_read_b64_tr_b16 v[194:195], v8 offset:50176
    v_mfma_f32_16x16x32_bf16 v[60:63], v[152:155], v[144:147], v[60:63]
    ds_read_b64_tr_b16 v[196:197], v9 offset:49152
    v_mfma_f32_16x16x32_bf16 v[64:67], v[156:159], v[136:139], v[64:67]
    ds_read_b64_tr_b16 v[198:199], v9 offset:50176
    v_mfma_f32_16x16x32_bf16 v[68:71], v[156:159], v[140:143], v[68:71]
    ds_read_b64_tr_b16 v[200:201], v10 offset:49152
    v_mfma_f32_16x16x32_bf16 v[72:75], v[156:159], v[144:147], v[72:75]
    ds_read_b64_tr_b16 v[202:203], v10 offset:50176
    v_mfma_f32_16x16x32_bf16 v[76:79], v[160:163], v[136:139], v[76:79]
    ds_read_b64_tr_b16 v[204:205], v11 offset:49152
    v_mfma_f32_16x16x32_bf16 v[80:83], v[160:163], v[140:143], v[80:83]
    ds_read_b64_tr_b16 v[206:207], v11 offset:50176
    v_mfma_f32_16x16x32_bf16 v[84:87], v[160:163], v[144:147], v[84:87]
    ds_read_b64_tr_b16 v[208:209], v12 offset:49152
    v_mfma_f32_16x16x32_bf16 v[88:91], v[164:167], v[136:139], v[88:91]
    ds_read_b64_tr_b16 v[210:211], v12 offset:50176
    v_mfma_f32_16x16x32_bf16 v[92:95], v[164:167], v[140:143], v[92:95]
    ds_read_b64_tr_b16 v[212:213], v13 offset:49152
    v_mfma_f32_16x16x32_bf16 v[96:99], v[164:167], v[144:147], v[96:99]
    ds_read_b64_tr_b16 v[214:215], v13 offset:50176
    v_mfma_f32_16x16x32_bf16 v[100:103], v[168:171], v[136:139], v[100:103]
    ds_read_b64_tr_b16 v[216:217], v14 offset:49152
    v_mfma_f32_16x16x32_bf16 v[104:107], v[168:171], v[140:143], v[104:107]
    ds_read_b64_tr_b16 v[218:219], v14 offset:50176
    v_mfma_f32_16x16x32_bf16 v[108:111], v[168:171], v[144:147], v[108:111]
    ds_read_b64_tr_b16 v[220:221], v15 offset:49152
    v_mfma_f32_16x16x32_bf16 v[112:115], v[172:175], v[136:139], v[112:115]
    ds_read_b64_tr_b16 v[222:223], v15 offset:50176
    v_mfma_f32_16x16x32_bf16 v[116:119], v[172:175], v[140:143], v[116:119]
    v_mfma_f32_16x16x32_bf16 v[120:123], v[172:175], v[144:147], v[120:123]
    v_mfma_f32_16x16x32_bf16 v[124:127], v[176:179], v[136:139], v[124:127]
    v_mfma_f32_16x16x32_bf16 v[128:131], v[176:179], v[140:143], v[128:131]
    v_mfma_f32_16x16x32_bf16 v[132:135], v[176:179], v[144:147], v[132:135]
    s_waitcnt lgkmcnt(0)
    s_barrier
    v_mfma_f32_16x16x32_bf16 v[40:43], v[192:195], v[180:183], v[40:43]
    ds_read_b128 v[136:139], v24 offset:12288
    v_mfma_f32_16x16x32_bf16 v[44:47], v[192:195], v[184:187], v[44:47]
    ds_read_b128 v[140:143], v24 offset:14336
    v_mfma_f32_16x16x32_bf16 v[48:51], v[192:195], v[188:191], v[48:51]
    ds_read_b128 v[144:147], v24 offset:16384
    v_mfma_f32_16x16x32_bf16 v[52:55], v[196:199], v[180:183], v[52:55]
    ds_read_b64_tr_b16 v[148:149], v8 offset:0
    v_mfma_f32_16x16x32_bf16 v[56:59], v[196:199], v[184:187], v[56:59]
    ds_read_b64_tr_b16 v[150:151], v8 offset:1024
    v_mfma_f32_16x16x32_bf16 v[60:63], v[196:199], v[188:191], v[60:63]
    ds_read_b64_tr_b16 v[152:153], v9 offset:0
    v_mfma_f32_16x16x32_bf16 v[64:67], v[200:203], v[180:183], v[64:67]
    ds_read_b64_tr_b16 v[154:155], v9 offset:1024
    v_mfma_f32_16x16x32_bf16 v[68:71], v[200:203], v[184:187], v[68:71]
    ds_read_b64_tr_b16 v[156:157], v10 offset:0
    v_mfma_f32_16x16x32_bf16 v[72:75], v[200:203], v[188:191], v[72:75]
    ds_read_b64_tr_b16 v[158:159], v10 offset:1024
    v_mfma_f32_16x16x32_bf16 v[76:79], v[204:207], v[180:183], v[76:79]
    ds_read_b64_tr_b16 v[160:161], v11 offset:0
    v_mfma_f32_16x16x32_bf16 v[80:83], v[204:207], v[184:187], v[80:83]
    ds_read_b64_tr_b16 v[162:163], v11 offset:1024
    v_mfma_f32_16x16x32_bf16 v[84:87], v[204:207], v[188:191], v[84:87]
    ds_read_b64_tr_b16 v[164:165], v12 offset:0
    v_mfma_f32_16x16x32_bf16 v[88:91], v[208:211], v[180:183], v[88:91]
    ds_read_b64_tr_b16 v[166:167], v12 offset:1024
    v_mfma_f32_16x16x32_bf16 v[92:95], v[208:211], v[184:187], v[92:95]
    ds_read_b64_tr_b16 v[168:169], v13 offset:0
    v_mfma_f32_16x16x32_bf16 v[96:99], v[208:211], v[188:191], v[96:99]
    ds_read_b64_tr_b16 v[170:171], v13 offset:1024
    v_mfma_f32_16x16x32_bf16 v[100:103], v[212:215], v[180:183], v[100:103]
    ds_read_b64_tr_b16 v[172:173], v14 offset:0
    v_mfma_f32_16x16x32_bf16 v[104:107], v[212:215], v[184:187], v[104:107]
    ds_read_b64_tr_b16 v[174:175], v14 offset:1024
    v_mfma_f32_16x16x32_bf16 v[108:111], v[212:215], v[188:191], v[108:111]
    ds_read_b64_tr_b16 v[176:177], v15 offset:0
    v_mfma_f32_16x16x32_bf16 v[112:115], v[216:219], v[180:183], v[112:115]
    ds_read_b64_tr_b16 v[178:179], v15 offset:1024
    v_mfma_f32_16x16x32_bf16 v[116:119], v[216:219], v[184:187], v[116:119]
    v_mfma_f32_16x16x32_bf16 v[120:123], v[216:219], v[188:191], v[120:123]
    v_mfma_f32_16x16x32_bf16 v[124:127], v[220:223], v[180:183], v[124:127]
    v_mfma_f32_16x16x32_bf16 v[128:131], v[220:223], v[184:187], v[128:131]
    v_mfma_f32_16x16x32_bf16 v[132:135], v[220:223], v[188:191], v[132:135]
    s_waitcnt lgkmcnt(0)
    s_barrier
    v_mfma_f32_16x16x32_bf16 v[40:43], v[148:151], v[136:139], v[40:43]
    ds_read_b128 v[180:183], v25 offset:12288
    v_mfma_f32_16x16x32_bf16 v[44:47], v[148:151], v[140:143], v[44:47]
    ds_read_b128 v[184:187], v25 offset:14336
    v_mfma_f32_16x16x32_bf16 v[48:51], v[148:151], v[144:147], v[48:51]
    ds_read_b128 v[188:191], v25 offset:16384
    v_mfma_f32_16x16x32_bf16 v[52:55], v[152:155], v[136:139], v[52:55]
    ds_read_b64_tr_b16 v[192:193], v8 offset:16384
    v_mfma_f32_16x16x32_bf16 v[56:59], v[152:155], v[140:143], v[56:59]
    ds_read_b64_tr_b16 v[194:195], v8 offset:17408
    v_mfma_f32_16x16x32_bf16 v[60:63], v[152:155], v[144:147], v[60:63]
    ds_read_b64_tr_b16 v[196:197], v9 offset:16384
    v_mfma_f32_16x16x32_bf16 v[64:67], v[156:159], v[136:139], v[64:67]
    ds_read_b64_tr_b16 v[198:199], v9 offset:17408
    v_mfma_f32_16x16x32_bf16 v[68:71], v[156:159], v[140:143], v[68:71]
    ds_read_b64_tr_b16 v[200:201], v10 offset:16384
    v_mfma_f32_16x16x32_bf16 v[72:75], v[156:159], v[144:147], v[72:75]
    ds_read_b64_tr_b16 v[202:203], v10 offset:17408
    v_mfma_f32_16x16x32_bf16 v[76:79], v[160:163], v[136:139], v[76:79]
    ds_read_b64_tr_b16 v[204:205], v11 offset:16384
    v_mfma_f32_16x16x32_bf16 v[80:83], v[160:163], v[140:143], v[80:83]
    ds_read_b64_tr_b16 v[206:207], v11 offset:17408
    v_mfma_f32_16x16x32_bf16 v[84:87], v[160:163], v[144:147], v[84:87]
    ds_read_b64_tr_b16 v[208:209], v12 offset:16384
    v_mfma_f32_16x16x32_bf16 v[88:91], v[164:167], v[136:139], v[88:91]
    ds_read_b64_tr_b16 v[210:211], v12 offset:17408
    v_mfma_f32_16x16x32_bf16 v[92:95], v[164:167], v[140:143], v[92:95]
    ds_read_b64_tr_b16 v[212:213], v13 offset:16384
    v_mfma_f32_16x16x32_bf16 v[96:99], v[164:167], v[144:147], v[96:99]
    ds_read_b64_tr_b16 v[214:215], v13 offset:17408
    v_mfma_f32_16x16x32_bf16 v[100:103], v[168:171], v[136:139], v[100:103]
    ds_read_b64_tr_b16 v[216:217], v14 offset:16384
    v_mfma_f32_16x16x32_bf16 v[104:107], v[168:171], v[140:143], v[104:107]
    ds_read_b64_tr_b16 v[218:219], v14 offset:17408
    v_mfma_f32_16x16x32_bf16 v[108:111], v[168:171], v[144:147], v[108:111]
    ds_read_b64_tr_b16 v[220:221], v15 offset:16384
    v_mfma_f32_16x16x32_bf16 v[112:115], v[172:175], v[136:139], v[112:115]
    ds_read_b64_tr_b16 v[222:223], v15 offset:17408
    v_mfma_f32_16x16x32_bf16 v[116:119], v[172:175], v[140:143], v[116:119]
    v_mfma_f32_16x16x32_bf16 v[120:123], v[172:175], v[144:147], v[120:123]
    v_mfma_f32_16x16x32_bf16 v[124:127], v[176:179], v[136:139], v[124:127]
    v_mfma_f32_16x16x32_bf16 v[128:131], v[176:179], v[140:143], v[128:131]
    v_mfma_f32_16x16x32_bf16 v[132:135], v[176:179], v[144:147], v[132:135]
    s_waitcnt lgkmcnt(0)
    s_barrier
    v_mfma_f32_16x16x32_bf16 v[40:43], v[192:195], v[180:183], v[40:43]
    ds_read_b128 v[136:139], v24 offset:24576
    v_mfma_f32_16x16x32_bf16 v[44:47], v[192:195], v[184:187], v[44:47]
    ds_read_b128 v[140:143], v24 offset:26624
    v_mfma_f32_16x16x32_bf16 v[48:51], v[192:195], v[188:191], v[48:51]
    ds_read_b128 v[144:147], v24 offset:28672
    v_mfma_f32_16x16x32_bf16 v[52:55], v[196:199], v[180:183], v[52:55]
    ds_read_b64_tr_b16 v[148:149], v8 offset:32768
    v_mfma_f32_16x16x32_bf16 v[56:59], v[196:199], v[184:187], v[56:59]
    ds_read_b64_tr_b16 v[150:151], v8 offset:33792
    v_mfma_f32_16x16x32_bf16 v[60:63], v[196:199], v[188:191], v[60:63]
    ds_read_b64_tr_b16 v[152:153], v9 offset:32768
    v_mfma_f32_16x16x32_bf16 v[64:67], v[200:203], v[180:183], v[64:67]
    ds_read_b64_tr_b16 v[154:155], v9 offset:33792
    v_mfma_f32_16x16x32_bf16 v[68:71], v[200:203], v[184:187], v[68:71]
    ds_read_b64_tr_b16 v[156:157], v10 offset:32768
    v_mfma_f32_16x16x32_bf16 v[72:75], v[200:203], v[188:191], v[72:75]
    ds_read_b64_tr_b16 v[158:159], v10 offset:33792
    v_mfma_f32_16x16x32_bf16 v[76:79], v[204:207], v[180:183], v[76:79]
    ds_read_b64_tr_b16 v[160:161], v11 offset:32768
    v_mfma_f32_16x16x32_bf16 v[80:83], v[204:207], v[184:187], v[80:83]
    ds_read_b64_tr_b16 v[162:163], v11 offset:33792
    v_mfma_f32_16x16x32_bf16 v[84:87], v[204:207], v[188:191], v[84:87]
    ds_read_b64_tr_b16 v[164:165], v12 offset:32768
    v_mfma_f32_16x16x32_bf16 v[88:91], v[208:211], v[180:183], v[88:91]
    ds_read_b64_tr_b16 v[166:167], v12 offset:33792
    v_mfma_f32_16x16x32_bf16 v[92:95], v[208:211], v[184:187], v[92:95]
    ds_read_b64_tr_b16 v[168:169], v13 offset:32768
    v_mfma_f32_16x16x32_bf16 v[96:99], v[208:211], v[188:191], v[96:99]
    ds_read_b64_tr_b16 v[170:171], v13 offset:33792
    v_mfma_f32_16x16x32_bf16 v[100:103], v[212:215], v[180:183], v[100:103]
    ds_read_b64_tr_b16 v[172:173], v14 offset:32768
    v_mfma_f32_16x16x32_bf16 v[104:107], v[212:215], v[184:187], v[104:107]
    ds_read_b64_tr_b16 v[174:175], v14 offset:33792
    v_mfma_f32_16x16x32_bf16 v[108:111], v[212:215], v[188:191], v[108:111]
    ds_read_b64_tr_b16 v[176:177], v15 offset:32768
    v_mfma_f32_16x16x32_bf16 v[112:115], v[216:219], v[180:183], v[112:115]
    ds_read_b64_tr_b16 v[178:179], v15 offset:33792
    v_mfma_f32_16x16x32_bf16 v[116:119], v[216:219], v[184:187], v[116:119]
    v_mfma_f32_16x16x32_bf16 v[120:123], v[216:219], v[188:191], v[120:123]
    v_mfma_f32_16x16x32_bf16 v[124:127], v[220:223], v[180:183], v[124:127]
    v_mfma_f32_16x16x32_bf16 v[128:131], v[220:223], v[184:187], v[128:131]
    v_mfma_f32_16x16x32_bf16 v[132:135], v[220:223], v[188:191], v[132:135]
    s_waitcnt lgkmcnt(0)
    s_barrier
    v_mfma_f32_16x16x32_bf16 v[40:43], v[148:151], v[136:139], v[40:43]
    ds_read_b128 v[180:183], v25 offset:24576
    v_mfma_f32_16x16x32_bf16 v[44:47], v[148:151], v[140:143], v[44:47]
    ds_read_b128 v[184:187], v25 offset:26624
    v_mfma_f32_16x16x32_bf16 v[48:51], v[148:151], v[144:147], v[48:51]
    ds_read_b128 v[188:191], v25 offset:28672
    v_mfma_f32_16x16x32_bf16 v[52:55], v[152:155], v[136:139], v[52:55]
    ds_read_b64_tr_b16 v[192:193], v8 offset:49152
    v_mfma_f32_16x16x32_bf16 v[56:59], v[152:155], v[140:143], v[56:59]
    ds_read_b64_tr_b16 v[194:195], v8 offset:50176
    v_mfma_f32_16x16x32_bf16 v[60:63], v[152:155], v[144:147], v[60:63]
    ds_read_b64_tr_b16 v[196:197], v9 offset:49152
    v_mfma_f32_16x16x32_bf16 v[64:67], v[156:159], v[136:139], v[64:67]
    ds_read_b64_tr_b16 v[198:199], v9 offset:50176
    v_mfma_f32_16x16x32_bf16 v[68:71], v[156:159], v[140:143], v[68:71]
    ds_read_b64_tr_b16 v[200:201], v10 offset:49152
    v_mfma_f32_16x16x32_bf16 v[72:75], v[156:159], v[144:147], v[72:75]
    ds_read_b64_tr_b16 v[202:203], v10 offset:50176
    v_mfma_f32_16x16x32_bf16 v[76:79], v[160:163], v[136:139], v[76:79]
    ds_read_b64_tr_b16 v[204:205], v11 offset:49152
    v_mfma_f32_16x16x32_bf16 v[80:83], v[160:163], v[140:143], v[80:83]
    ds_read_b64_tr_b16 v[206:207], v11 offset:50176
    v_mfma_f32_16x16x32_bf16 v[84:87], v[160:163], v[144:147], v[84:87]
    ds_read_b64_tr_b16 v[208:209], v12 offset:49152
    v_mfma_f32_16x16x32_bf16 v[88:91], v[164:167], v[136:139], v[88:91]
    ds_read_b64_tr_b16 v[210:211], v12 offset:50176
    v_mfma_f32_16x16x32_bf16 v[92:95], v[164:167], v[140:143], v[92:95]
    ds_read_b64_tr_b16 v[212:213], v13 offset:49152
    v_mfma_f32_16x16x32_bf16 v[96:99], v[164:167], v[144:147], v[96:99]
    ds_read_b64_tr_b16 v[214:215], v13 offset:50176
    v_mfma_f32_16x16x32_bf16 v[100:103], v[168:171], v[136:139], v[100:103]
    ds_read_b64_tr_b16 v[216:217], v14 offset:49152
    v_mfma_f32_16x16x32_bf16 v[104:107], v[168:171], v[140:143], v[104:107]
    ds_read_b64_tr_b16 v[218:219], v14 offset:50176
    v_mfma_f32_16x16x32_bf16 v[108:111], v[168:171], v[144:147], v[108:111]
    ds_read_b64_tr_b16 v[220:221], v15 offset:49152
    v_mfma_f32_16x16x32_bf16 v[112:115], v[172:175], v[136:139], v[112:115]
    ds_read_b64_tr_b16 v[222:223], v15 offset:50176
    v_mfma_f32_16x16x32_bf16 v[116:119], v[172:175], v[140:143], v[116:119]
    v_mfma_f32_16x16x32_bf16 v[120:123], v[172:175], v[144:147], v[120:123]
    v_mfma_f32_16x16x32_bf16 v[124:127], v[176:179], v[136:139], v[124:127]
    v_mfma_f32_16x16x32_bf16 v[128:131], v[176:179], v[140:143], v[128:131]
    v_mfma_f32_16x16x32_bf16 v[132:135], v[176:179], v[144:147], v[132:135]
    s_waitcnt lgkmcnt(0)
    s_barrier
    v_mfma_f32_16x16x32_bf16 v[40:43], v[192:195], v[180:183], v[40:43]
    ds_read_b128 v[136:139], v24 offset:0
    v_mfma_f32_16x16x32_bf16 v[44:47], v[192:195], v[184:187], v[44:47]
    ds_read_b128 v[140:143], v24 offset:2048
    v_mfma_f32_16x16x32_bf16 v[48:51], v[192:195], v[188:191], v[48:51]
    ds_read_b128 v[144:147], v24 offset:4096
    v_mfma_f32_16x16x32_bf16 v[52:55], v[196:199], v[180:183], v[52:55]
    ds_read_b64_tr_b16 v[148:149], v8 offset:0
    v_mfma_f32_16x16x32_bf16 v[56:59], v[196:199], v[184:187], v[56:59]
    ds_read_b64_tr_b16 v[150:151], v8 offset:1024
    v_mfma_f32_16x16x32_bf16 v[60:63], v[196:199], v[188:191], v[60:63]
    ds_read_b64_tr_b16 v[152:153], v9 offset:0
    v_mfma_f32_16x16x32_bf16 v[64:67], v[200:203], v[180:183], v[64:67]
    ds_read_b64_tr_b16 v[154:155], v9 offset:1024
    v_mfma_f32_16x16x32_bf16 v[68:71], v[200:203], v[184:187], v[68:71]
    ds_read_b64_tr_b16 v[156:157], v10 offset:0
    v_mfma_f32_16x16x32_bf16 v[72:75], v[200:203], v[188:191], v[72:75]
    ds_read_b64_tr_b16 v[158:159], v10 offset:1024
    v_mfma_f32_16x16x32_bf16 v[76:79], v[204:207], v[180:183], v[76:79]
    ds_read_b64_tr_b16 v[160:161], v11 offset:0
    v_mfma_f32_16x16x32_bf16 v[80:83], v[204:207], v[184:187], v[80:83]
    ds_read_b64_tr_b16 v[162:163], v11 offset:1024
    v_mfma_f32_16x16x32_bf16 v[84:87], v[204:207], v[188:191], v[84:87]
    ds_read_b64_tr_b16 v[164:165], v12 offset:0
    v_mfma_f32_16x16x32_bf16 v[88:91], v[208:211], v[180:183], v[88:91]
    ds_read_b64_tr_b16 v[166:167], v12 offset:1024
    v_mfma_f32_16x16x32_bf16 v[92:95], v[208:211], v[184:187], v[92:95]
    ds_read_b64_tr_b16 v[168:169], v13 offset:0
    v_mfma_f32_16x16x32_bf16 v[96:99], v[208:211], v[188:191], v[96:99]
    ds_read_b64_tr_b16 v[170:171], v13 offset:1024
    v_mfma_f32_16x16x32_bf16 v[100:103], v[212:215], v[180:183], v[100:103]
    ds_read_b64_tr_b16 v[172:173], v14 offset:0
    v_mfma_f32_16x16x32_bf16 v[104:107], v[212:215], v[184:187], v[104:107]
    ds_read_b64_tr_b16 v[174:175], v14 offset:1024
    v_mfma_f32_16x16x32_bf16 v[108:111], v[212:215], v[188:191], v[108:111]
    ds_read_b64_tr_b16 v[176:177], v15 offset:0
    v_mfma_f32_16x16x32_bf16 v[112:115], v[216:219], v[180:183], v[112:115]
    ds_read_b64_tr_b16 v[178:179], v15 offset:1024
    v_mfma_f32_16x16x32_bf16 v[116:119], v[216:219], v[184:187], v[116:119]
    v_mfma_f32_16x16x32_bf16 v[120:123], v[216:219], v[188:191], v[120:123]
    v_mfma_f32_16x16x32_bf16 v[124:127], v[220:223], v[180:183], v[124:127]
    v_mfma_f32_16x16x32_bf16 v[128:131], v[220:223], v[184:187], v[128:131]
    v_mfma_f32_16x16x32_bf16 v[132:135], v[220:223], v[188:191], v[132:135]
    s_waitcnt lgkmcnt(0)
    s_barrier
    v_mfma_f32_16x16x32_bf16 v[40:43], v[148:151], v[136:139], v[40:43]
    ds_read_b128 v[180:183], v25 offset:0
    v_mfma_f32_16x16x32_bf16 v[44:47], v[148:151], v[140:143], v[44:47]
    ds_read_b128 v[184:187], v25 offset:2048
    v_mfma_f32_16x16x32_bf16 v[48:51], v[148:151], v[144:147], v[48:51]
    ds_read_b128 v[188:191], v25 offset:4096
    v_mfma_f32_16x16x32_bf16 v[52:55], v[152:155], v[136:139], v[52:55]
    ds_read_b64_tr_b16 v[192:193], v8 offset:16384
    v_mfma_f32_16x16x32_bf16 v[56:59], v[152:155], v[140:143], v[56:59]
    ds_read_b64_tr_b16 v[194:195], v8 offset:17408
    v_mfma_f32_16x16x32_bf16 v[60:63], v[152:155], v[144:147], v[60:63]
    ds_read_b64_tr_b16 v[196:197], v9 offset:16384
    v_mfma_f32_16x16x32_bf16 v[64:67], v[156:159], v[136:139], v[64:67]
    ds_read_b64_tr_b16 v[198:199], v9 offset:17408
    v_mfma_f32_16x16x32_bf16 v[68:71], v[156:159], v[140:143], v[68:71]
    ds_read_b64_tr_b16 v[200:201], v10 offset:16384
    v_mfma_f32_16x16x32_bf16 v[72:75], v[156:159], v[144:147], v[72:75]
    ds_read_b64_tr_b16 v[202:203], v10 offset:17408
    v_mfma_f32_16x16x32_bf16 v[76:79], v[160:163], v[136:139], v[76:79]
    ds_read_b64_tr_b16 v[204:205], v11 offset:16384
    v_mfma_f32_16x16x32_bf16 v[80:83], v[160:163], v[140:143], v[80:83]
    ds_read_b64_tr_b16 v[206:207], v11 offset:17408
    v_mfma_f32_16x16x32_bf16 v[84:87], v[160:163], v[144:147], v[84:87]
    ds_read_b64_tr_b16 v[208:209], v12 offset:16384
    v_mfma_f32_16x16x32_bf16 v[88:91], v[164:167], v[136:139], v[88:91]
    ds_read_b64_tr_b16 v[210:211], v12 offset:17408
    v_mfma_f32_16x16x32_bf16 v[92:95], v[164:167], v[140:143], v[92:95]
    ds_read_b64_tr_b16 v[212:213], v13 offset:16384
    v_mfma_f32_16x16x32_bf16 v[96:99], v[164:167], v[144:147], v[96:99]
    ds_read_b64_tr_b16 v[214:215], v13 offset:17408
    v_mfma_f32_16x16x32_bf16 v[100:103], v[168:171], v[136:139], v[100:103]
    ds_read_b64_tr_b16 v[216:217], v14 offset:16384
    v_mfma_f32_16x16x32_bf16 v[104:107], v[168:171], v[140:143], v[104:107]
    ds_read_b64_tr_b16 v[218:219], v14 offset:17408
    v_mfma_f32_16x16x32_bf16 v[108:111], v[168:171], v[144:147], v[108:111]
    ds_read_b64_tr_b16 v[220:221], v15 offset:16384
    v_mfma_f32_16x16x32_bf16 v[112:115], v[172:175], v[136:139], v[112:115]
    ds_read_b64_tr_b16 v[222:223], v15 offset:17408
    v_mfma_f32_16x16x32_bf16 v[116:119], v[172:175], v[140:143], v[116:119]
    v_mfma_f32_16x16x32_bf16 v[120:123], v[172:175], v[144:147], v[120:123]
    v_mfma_f32_16x16x32_bf16 v[124:127], v[176:179], v[136:139], v[124:127]
    v_mfma_f32_16x16x32_bf16 v[128:131], v[176:179], v[140:143], v[128:131]
    v_mfma_f32_16x16x32_bf16 v[132:135], v[176:179], v[144:147], v[132:135]
    s_waitcnt lgkmcnt(0)
    s_barrier
    v_mfma_f32_16x16x32_bf16 v[40:43], v[192:195], v[180:183], v[40:43]
    ds_read_b128 v[136:139], v24 offset:12288
    v_mfma_f32_16x16x32_bf16 v[44:47], v[192:195], v[184:187], v[44:47]
    ds_read_b128 v[140:143], v24 offset:14336
    v_mfma_f32_16x16x32_bf16 v[48:51], v[192:195], v[188:191], v[48:51]
    ds_read_b128 v[144:147], v24 offset:16384
    v_mfma_f32_16x16x32_bf16 v[52:55], v[196:199], v[180:183], v[52:55]
    ds_read_b64_tr_b16 v[148:149], v8 offset:32768
    v_mfma_f32_16x16x32_bf16 v[56:59], v[196:199], v[184:187], v[56:59]
    ds_read_b64_tr_b16 v[150:151], v8 offset:33792
    v_mfma_f32_16x16x32_bf16 v[60:63], v[196:199], v[188:191], v[60:63]
    ds_read_b64_tr_b16 v[152:153], v9 offset:32768
    v_mfma_f32_16x16x32_bf16 v[64:67], v[200:203], v[180:183], v[64:67]
    ds_read_b64_tr_b16 v[154:155], v9 offset:33792
    v_mfma_f32_16x16x32_bf16 v[68:71], v[200:203], v[184:187], v[68:71]
    ds_read_b64_tr_b16 v[156:157], v10 offset:32768
    v_mfma_f32_16x16x32_bf16 v[72:75], v[200:203], v[188:191], v[72:75]
    ds_read_b64_tr_b16 v[158:159], v10 offset:33792
    v_mfma_f32_16x16x32_bf16 v[76:79], v[204:207], v[180:183], v[76:79]
    ds_read_b64_tr_b16 v[160:161], v11 offset:32768
    v_mfma_f32_16x16x32_bf16 v[80:83], v[204:207], v[184:187], v[80:83]
    ds_read_b64_tr_b16 v[162:163], v11 offset:33792
    v_mfma_f32_16x16x32_bf16 v[84:87], v[204:207], v[188:191], v[84:87]
    ds_read_b64_tr_b16 v[164:165], v12 offset:32768
    v_mfma_f32_16x16x32_bf16 v[88:91], v[208:211], v[180:183], v[88:91]
    ds_read_b64_tr_b16 v[166:167], v12 offset:33792
    v_mfma_f32_16x16x32_bf16 v[92:95], v[208:211], v[184:187], v[92:95]
    ds_read_b64_tr_b16 v[168:169], v13 offset:32768
    v_mfma_f32_16x16x32_bf16 v[96:99], v[208:211], v[188:191], v[96:99]
    ds_read_b64_tr_b16 v[170:171], v13 offset:33792
    v_mfma_f32_16x16x32_bf16 v[100:103], v[212:215], v[180:183], v[100:103]
    ds_read_b64_tr_b16 v[172:173], v14 offset:32768
    v_mfma_f32_16x16x32_bf16 v[104:107], v[212:215], v[184:187], v[104:107]
    ds_read_b64_tr_b16 v[174:175], v14 offset:33792
    v_mfma_f32_16x16x32_bf16 v[108:111], v[212:215], v[188:191], v[108:111]
    ds_read_b64_tr_b16 v[176:177], v15 offset:32768
    v_mfma_f32_16x16x32_bf16 v[112:115], v[216:219], v[180:183], v[112:115]
    ds_read_b64_tr_b16 v[178:179], v15 offset:33792
    v_mfma_f32_16x16x32_bf16 v[116:119], v[216:219], v[184:187], v[116:119]
    v_mfma_f32_16x16x32_bf16 v[120:123], v[216:219], v[188:191], v[120:123]
    v_mfma_f32_16x16x32_bf16 v[124:127], v[220:223], v[180:183], v[124:127]
    v_mfma_f32_16x16x32_bf16 v[128:131], v[220:223], v[184:187], v[128:131]
    v_mfma_f32_16x16x32_bf16 v[132:135], v[220:223], v[188:191], v[132:135]
    s_waitcnt lgkmcnt(0)
    s_barrier
    v_mfma_f32_16x16x32_bf16 v[40:43], v[148:151], v[136:139], v[40:43]
    ds_read_b128 v[180:183], v25 offset:12288
    v_mfma_f32_16x16x32_bf16 v[44:47], v[148:151], v[140:143], v[44:47]
    ds_read_b128 v[184:187], v25 offset:14336
    v_mfma_f32_16x16x32_bf16 v[48:51], v[148:151], v[144:147], v[48:51]
    ds_read_b128 v[188:191], v25 offset:16384
    v_mfma_f32_16x16x32_bf16 v[52:55], v[152:155], v[136:139], v[52:55]
    ds_read_b64_tr_b16 v[192:193], v8 offset:49152
    v_mfma_f32_16x16x32_bf16 v[56:59], v[152:155], v[140:143], v[56:59]
    ds_read_b64_tr_b16 v[194:195], v8 offset:50176
    v_mfma_f32_16x16x32_bf16 v[60:63], v[152:155], v[144:147], v[60:63]
    ds_read_b64_tr_b16 v[196:197], v9 offset:49152
    v_mfma_f32_16x16x32_bf16 v[64:67], v[156:159], v[136:139], v[64:67]
    ds_read_b64_tr_b16 v[198:199], v9 offset:50176
    v_mfma_f32_16x16x32_bf16 v[68:71], v[156:159], v[140:143], v[68:71]
    ds_read_b64_tr_b16 v[200:201], v10 offset:49152
    v_mfma_f32_16x16x32_bf16 v[72:75], v[156:159], v[144:147], v[72:75]
    ds_read_b64_tr_b16 v[202:203], v10 offset:50176
    v_mfma_f32_16x16x32_bf16 v[76:79], v[160:163], v[136:139], v[76:79]
    ds_read_b64_tr_b16 v[204:205], v11 offset:49152
    v_mfma_f32_16x16x32_bf16 v[80:83], v[160:163], v[140:143], v[80:83]
    ds_read_b64_tr_b16 v[206:207], v11 offset:50176
    v_mfma_f32_16x16x32_bf16 v[84:87], v[160:163], v[144:147], v[84:87]
    ds_read_b64_tr_b16 v[208:209], v12 offset:49152
    v_mfma_f32_16x16x32_bf16 v[88:91], v[164:167], v[136:139], v[88:91]
    ds_read_b64_tr_b16 v[210:211], v12 offset:50176
    v_mfma_f32_16x16x32_bf16 v[92:95], v[164:167], v[140:143], v[92:95]
    ds_read_b64_tr_b16 v[212:213], v13 offset:49152
    v_mfma_f32_16x16x32_bf16 v[96:99], v[164:167], v[144:147], v[96:99]
    ds_read_b64_tr_b16 v[214:215], v13 offset:50176
    v_mfma_f32_16x16x32_bf16 v[100:103], v[168:171], v[136:139], v[100:103]
    ds_read_b64_tr_b16 v[216:217], v14 offset:49152
    v_mfma_f32_16x16x32_bf16 v[104:107], v[168:171], v[140:143], v[104:107]
    ds_read_b64_tr_b16 v[218:219], v14 offset:50176
    v_mfma_f32_16x16x32_bf16 v[108:111], v[168:171], v[144:147], v[108:111]
    ds_read_b64_tr_b16 v[220:221], v15 offset:49152
    v_mfma_f32_16x16x32_bf16 v[112:115], v[172:175], v[136:139], v[112:115]
    ds_read_b64_tr_b16 v[222:223], v15 offset:50176
    v_mfma_f32_16x16x32_bf16 v[116:119], v[172:175], v[140:143], v[116:119]
    v_mfma_f32_16x16x32_bf16 v[120:123], v[172:175], v[144:147], v[120:123]
    v_mfma_f32_16x16x32_bf16 v[124:127], v[176:179], v[136:139], v[124:127]
    v_mfma_f32_16x16x32_bf16 v[128:131], v[176:179], v[140:143], v[128:131]
    v_mfma_f32_16x16x32_bf16 v[132:135], v[176:179], v[144:147], v[132:135]
    s_waitcnt lgkmcnt(0)
    s_barrier
    v_mfma_f32_16x16x32_bf16 v[40:43], v[192:195], v[180:183], v[40:43]
    ds_read_b128 v[136:139], v24 offset:24576
    v_mfma_f32_16x16x32_bf16 v[44:47], v[192:195], v[184:187], v[44:47]
    ds_read_b128 v[140:143], v24 offset:26624
    v_mfma_f32_16x16x32_bf16 v[48:51], v[192:195], v[188:191], v[48:51]
    ds_read_b128 v[144:147], v24 offset:28672
    v_mfma_f32_16x16x32_bf16 v[52:55], v[196:199], v[180:183], v[52:55]
    ds_read_b64_tr_b16 v[148:149], v8 offset:0
    v_mfma_f32_16x16x32_bf16 v[56:59], v[196:199], v[184:187], v[56:59]
    ds_read_b64_tr_b16 v[150:151], v8 offset:1024
    v_mfma_f32_16x16x32_bf16 v[60:63], v[196:199], v[188:191], v[60:63]
    ds_read_b64_tr_b16 v[152:153], v9 offset:0
    v_mfma_f32_16x16x32_bf16 v[64:67], v[200:203], v[180:183], v[64:67]
    ds_read_b64_tr_b16 v[154:155], v9 offset:1024
    v_mfma_f32_16x16x32_bf16 v[68:71], v[200:203], v[184:187], v[68:71]
    ds_read_b64_tr_b16 v[156:157], v10 offset:0
    v_mfma_f32_16x16x32_bf16 v[72:75], v[200:203], v[188:191], v[72:75]
    ds_read_b64_tr_b16 v[158:159], v10 offset:1024
    v_mfma_f32_16x16x32_bf16 v[76:79], v[204:207], v[180:183], v[76:79]
    ds_read_b64_tr_b16 v[160:161], v11 offset:0
    v_mfma_f32_16x16x32_bf16 v[80:83], v[204:207], v[184:187], v[80:83]
    ds_read_b64_tr_b16 v[162:163], v11 offset:1024
    v_mfma_f32_16x16x32_bf16 v[84:87], v[204:207], v[188:191], v[84:87]
    ds_read_b64_tr_b16 v[164:165], v12 offset:0
    v_mfma_f32_16x16x32_bf16 v[88:91], v[208:211], v[180:183], v[88:91]
    ds_read_b64_tr_b16 v[166:167], v12 offset:1024
    v_mfma_f32_16x16x32_bf16 v[92:95], v[208:211], v[184:187], v[92:95]
    ds_read_b64_tr_b16 v[168:169], v13 offset:0
    v_mfma_f32_16x16x32_bf16 v[96:99], v[208:211], v[188:191], v[96:99]
    ds_read_b64_tr_b16 v[170:171], v13 offset:1024
    v_mfma_f32_16x16x32_bf16 v[100:103], v[212:215], v[180:183], v[100:103]
    ds_read_b64_tr_b16 v[172:173], v14 offset:0
    v_mfma_f32_16x16x32_bf16 v[104:107], v[212:215], v[184:187], v[104:107]
    ds_read_b64_tr_b16 v[174:175], v14 offset:1024
    v_mfma_f32_16x16x32_bf16 v[108:111], v[212:215], v[188:191], v[108:111]
    ds_read_b64_tr_b16 v[176:177], v15 offset:0
    v_mfma_f32_16x16x32_bf16 v[112:115], v[216:219], v[180:183], v[112:115]
    ds_read_b64_tr_b16 v[178:179], v15 offset:1024
    v_mfma_f32_16x16x32_bf16 v[116:119], v[216:219], v[184:187], v[116:119]
    v_mfma_f32_16x16x32_bf16 v[120:123], v[216:219], v[188:191], v[120:123]
    v_mfma_f32_16x16x32_bf16 v[124:127], v[220:223], v[180:183], v[124:127]
    v_mfma_f32_16x16x32_bf16 v[128:131], v[220:223], v[184:187], v[128:131]
    v_mfma_f32_16x16x32_bf16 v[132:135], v[220:223], v[188:191], v[132:135]
    s_waitcnt lgkmcnt(0)
    s_barrier
    v_mfma_f32_16x16x32_bf16 v[40:43], v[148:151], v[136:139], v[40:43]
    ds_read_b128 v[180:183], v25 offset:24576
    v_mfma_f32_16x16x32_bf16 v[44:47], v[148:151], v[140:143], v[44:47]
    ds_read_b128 v[184:187], v25 offset:26624
    v_mfma_f32_16x16x32_bf16 v[48:51], v[148:151], v[144:147], v[48:51]
    ds_read_b128 v[188:191], v25 offset:28672
    v_mfma_f32_16x16x32_bf16 v[52:55], v[152:155], v[136:139], v[52:55]
    ds_read_b64_tr_b16 v[192:193], v8 offset:16384
    v_mfma_f32_16x16x32_bf16 v[56:59], v[152:155], v[140:143], v[56:59]
    ds_read_b64_tr_b16 v[194:195], v8 offset:17408
    v_mfma_f32_16x16x32_bf16 v[60:63], v[152:155], v[144:147], v[60:63]
    ds_read_b64_tr_b16 v[196:197], v9 offset:16384
    v_mfma_f32_16x16x32_bf16 v[64:67], v[156:159], v[136:139], v[64:67]
    ds_read_b64_tr_b16 v[198:199], v9 offset:17408
    v_mfma_f32_16x16x32_bf16 v[68:71], v[156:159], v[140:143], v[68:71]
    ds_read_b64_tr_b16 v[200:201], v10 offset:16384
    v_mfma_f32_16x16x32_bf16 v[72:75], v[156:159], v[144:147], v[72:75]
    ds_read_b64_tr_b16 v[202:203], v10 offset:17408
    v_mfma_f32_16x16x32_bf16 v[76:79], v[160:163], v[136:139], v[76:79]
    ds_read_b64_tr_b16 v[204:205], v11 offset:16384
    v_mfma_f32_16x16x32_bf16 v[80:83], v[160:163], v[140:143], v[80:83]
    ds_read_b64_tr_b16 v[206:207], v11 offset:17408
    v_mfma_f32_16x16x32_bf16 v[84:87], v[160:163], v[144:147], v[84:87]
    ds_read_b64_tr_b16 v[208:209], v12 offset:16384
    v_mfma_f32_16x16x32_bf16 v[88:91], v[164:167], v[136:139], v[88:91]
    ds_read_b64_tr_b16 v[210:211], v12 offset:17408
    v_mfma_f32_16x16x32_bf16 v[92:95], v[164:167], v[140:143], v[92:95]
    ds_read_b64_tr_b16 v[212:213], v13 offset:16384
    v_mfma_f32_16x16x32_bf16 v[96:99], v[164:167], v[144:147], v[96:99]
    ds_read_b64_tr_b16 v[214:215], v13 offset:17408
    v_mfma_f32_16x16x32_bf16 v[100:103], v[168:171], v[136:139], v[100:103]
    ds_read_b64_tr_b16 v[216:217], v14 offset:16384
    v_mfma_f32_16x16x32_bf16 v[104:107], v[168:171], v[140:143], v[104:107]
    ds_read_b64_tr_b16 v[218:219], v14 offset:17408
    v_mfma_f32_16x16x32_bf16 v[108:111], v[168:171], v[144:147], v[108:111]
    ds_read_b64_tr_b16 v[220:221], v15 offset:16384
    v_mfma_f32_16x16x32_bf16 v[112:115], v[172:175], v[136:139], v[112:115]
    ds_read_b64_tr_b16 v[222:223], v15 offset:17408
    v_mfma_f32_16x16x32_bf16 v[116:119], v[172:175], v[140:143], v[116:119]
    v_mfma_f32_16x16x32_bf16 v[120:123], v[172:175], v[144:147], v[120:123]
    v_mfma_f32_16x16x32_bf16 v[124:127], v[176:179], v[136:139], v[124:127]
    v_mfma_f32_16x16x32_bf16 v[128:131], v[176:179], v[140:143], v[128:131]
    v_mfma_f32_16x16x32_bf16 v[132:135], v[176:179], v[144:147], v[132:135]
    s_waitcnt lgkmcnt(0)
    s_barrier
    v_mfma_f32_16x16x32_bf16 v[40:43], v[192:195], v[180:183], v[40:43]
    ds_read_b64 v[136:137], v16 offset:0
    v_xor_b32 v8, 0, v27
    v_mfma_f32_16x16x32_bf16 v[52:55], v[196:199], v[180:183], v[52:55]
    ds_read_b64 v[138:139], v17 offset:0
    v_xor_b32 v9, 32, v27
    v_mfma_f32_16x16x32_bf16 v[64:67], v[200:203], v[180:183], v[64:67]
    ds_read_b64 v[152:153], v16 offset:16384
    v_xor_b32 v10, 64, v27
    v_mfma_f32_16x16x32_bf16 v[76:79], v[204:207], v[180:183], v[76:79]
    ds_read_b64 v[154:155], v17 offset:16384
    v_xor_b32 v11, 96, v27
    v_mfma_f32_16x16x32_bf16 v[88:91], v[208:211], v[180:183], v[88:91]
    ds_read_b64 v[168:169], v16 offset:32768
    v_xor_b32 v12, 128, v27
    v_mfma_f32_16x16x32_bf16 v[100:103], v[212:215], v[180:183], v[100:103]
    ds_read_b64 v[170:171], v17 offset:32768
    v_xor_b32 v13, 160, v27
    v_mfma_f32_16x16x32_bf16 v[112:115], v[216:219], v[180:183], v[112:115]
    ds_read_b64 v[140:141], v18 offset:0
    v_xor_b32 v14, 192, v27
    v_mfma_f32_16x16x32_bf16 v[124:127], v[220:223], v[180:183], v[124:127]
    ds_read_b64 v[142:143], v19 offset:0
    v_xor_b32 v15, 224, v27
    v_mfma_f32_16x16x32_bf16 v[44:47], v[192:195], v[184:187], v[44:47]
    ds_read_b64 v[156:157], v18 offset:16384
    ds_read_b64 v[158:159], v19 offset:16384
    v_mfma_f32_16x16x32_bf16 v[56:59], v[196:199], v[184:187], v[56:59]
    ds_read_b64 v[172:173], v18 offset:32768
    ds_read_b64 v[174:175], v19 offset:32768
    v_mfma_f32_16x16x32_bf16 v[68:71], v[200:203], v[184:187], v[68:71]
    v_mfma_f32_16x16x32_bf16 v[80:83], v[204:207], v[184:187], v[80:83]
    v_mfma_f32_16x16x32_bf16 v[92:95], v[208:211], v[184:187], v[92:95]
    ds_read_b64 v[144:145], v20 offset:0
    v_cvt_pk_bf16_f32 v40, v40, v41
    v_mfma_f32_16x16x32_bf16 v[104:107], v[212:215], v[184:187], v[104:107]
    ds_read_b64 v[146:147], v21 offset:0
    v_cvt_pk_bf16_f32 v41, v42, v43
    v_mfma_f32_16x16x32_bf16 v[116:119], v[216:219], v[184:187], v[116:119]
    ds_read_b64 v[160:161], v20 offset:16384
    v_cvt_pk_bf16_f32 v42, v52, v53
    v_mfma_f32_16x16x32_bf16 v[128:131], v[220:223], v[184:187], v[128:131]
    ds_read_b64 v[162:163], v21 offset:16384
    v_cvt_pk_bf16_f32 v43, v54, v55
    v_mfma_f32_16x16x32_bf16 v[48:51], v[192:195], v[188:191], v[48:51]
    ds_read_b64 v[176:177], v20 offset:32768
    v_cvt_pk_bf16_f32 v64, v64, v65
    v_mfma_f32_16x16x32_bf16 v[60:63], v[196:199], v[188:191], v[60:63]
    ds_read_b64 v[178:179], v21 offset:32768
    v_cvt_pk_bf16_f32 v65, v66, v67
    v_mfma_f32_16x16x32_bf16 v[72:75], v[200:203], v[188:191], v[72:75]
    ds_read_b64 v[148:149], v22 offset:0
    v_cvt_pk_bf16_f32 v66, v76, v77
    v_mfma_f32_16x16x32_bf16 v[84:87], v[204:207], v[188:191], v[84:87]
    ds_read_b64 v[150:151], v23 offset:0
    v_cvt_pk_bf16_f32 v67, v78, v79
    v_mfma_f32_16x16x32_bf16 v[96:99], v[208:211], v[188:191], v[96:99]
    ds_read_b64 v[164:165], v22 offset:16384
    v_cvt_pk_bf16_f32 v88, v88, v89
    v_mfma_f32_16x16x32_bf16 v[108:111], v[212:215], v[188:191], v[108:111]
    ds_read_b64 v[166:167], v23 offset:16384
    v_cvt_pk_bf16_f32 v89, v90, v91
    v_mfma_f32_16x16x32_bf16 v[120:123], v[216:219], v[188:191], v[120:123]
    ds_read_b64 v[224:225], v22 offset:32768
    v_cvt_pk_bf16_f32 v90, v100, v101
    v_mfma_f32_16x16x32_bf16 v[132:135], v[220:223], v[188:191], v[132:135]
    ds_read_b64 v[226:227], v23 offset:32768
    v_cvt_pk_bf16_f32 v91, v102, v103
    v_cvt_pk_bf16_f32 v112, v112, v113
    v_cvt_pk_bf16_f32 v113, v114, v115
    v_cvt_pk_bf16_f32 v114, v124, v125
    v_cvt_pk_bf16_f32 v115, v126, v127
    s_waitcnt lgkmcnt(6)
    v_mfma_f32_16x16x32_bf16 v[180:183], v[136:139], v[40:43], 0
    v_cvt_pk_bf16_f32 v44, v44, v45
    v_cvt_pk_bf16_f32 v45, v46, v47
    v_mfma_f32_16x16x32_bf16 v[184:187], v[152:155], v[40:43], 0
    v_cvt_pk_bf16_f32 v46, v56, v57
    v_cvt_pk_bf16_f32 v47, v58, v59
    v_mfma_f32_16x16x32_bf16 v[188:191], v[168:171], v[40:43], 0
    v_cvt_pk_bf16_f32 v68, v68, v69
    v_cvt_pk_bf16_f32 v69, v70, v71
    v_mfma_f32_16x16x32_bf16 v[180:183], v[140:143], v[64:67], v[180:183]
    v_cvt_pk_bf16_f32 v70, v80, v81
    v_cvt_pk_bf16_f32 v71, v82, v83
    v_mfma_f32_16x16x32_bf16 v[184:187], v[156:159], v[64:67], v[184:187]
    v_cvt_pk_bf16_f32 v92, v92, v93
    v_cvt_pk_bf16_f32 v93, v94, v95
    v_mfma_f32_16x16x32_bf16 v[188:191], v[172:175], v[64:67], v[188:191]
    v_cvt_pk_bf16_f32 v94, v104, v105
    v_cvt_pk_bf16_f32 v95, v106, v107
    v_mfma_f32_16x16x32_bf16 v[180:183], v[144:147], v[88:91], v[180:183]
    v_cvt_pk_bf16_f32 v116, v116, v117
    v_cvt_pk_bf16_f32 v117, v118, v119
    v_mfma_f32_16x16x32_bf16 v[184:187], v[160:163], v[88:91], v[184:187]
    v_cvt_pk_bf16_f32 v118, v128, v129
    v_cvt_pk_bf16_f32 v119, v130, v131
    v_mfma_f32_16x16x32_bf16 v[188:191], v[176:179], v[88:91], v[188:191]
    s_waitcnt lgkmcnt(0)
    v_mfma_f32_16x16x32_bf16 v[180:183], v[148:151], v[112:115], v[180:183]
    v_cvt_pk_bf16_f32 v48, v48, v49
    v_cvt_pk_bf16_f32 v49, v50, v51
    v_mfma_f32_16x16x32_bf16 v[184:187], v[164:167], v[112:115], v[184:187]
    v_cvt_pk_bf16_f32 v50, v60, v61
    v_cvt_pk_bf16_f32 v51, v62, v63
    v_mfma_f32_16x16x32_bf16 v[188:191], v[224:227], v[112:115], v[188:191]
    v_cvt_pk_bf16_f32 v72, v72, v73
    v_cvt_pk_bf16_f32 v73, v74, v75
    v_mfma_f32_16x16x32_bf16 v[192:195], v[136:139], v[44:47], 0
    v_cvt_pk_bf16_f32 v74, v84, v85
    v_cvt_pk_bf16_f32 v75, v86, v87
    v_mfma_f32_16x16x32_bf16 v[196:199], v[152:155], v[44:47], 0
    v_cvt_pk_bf16_f32 v96, v96, v97
    v_cvt_pk_bf16_f32 v97, v98, v99
    v_mfma_f32_16x16x32_bf16 v[200:203], v[168:171], v[44:47], 0
    v_cvt_pk_bf16_f32 v98, v108, v109
    v_cvt_pk_bf16_f32 v99, v110, v111
    v_mfma_f32_16x16x32_bf16 v[192:195], v[140:143], v[68:71], v[192:195]
    v_cvt_pk_bf16_f32 v120, v120, v121
    v_cvt_pk_bf16_f32 v121, v122, v123
    v_mfma_f32_16x16x32_bf16 v[196:199], v[156:159], v[68:71], v[196:199]
    v_cvt_pk_bf16_f32 v122, v132, v133
    v_cvt_pk_bf16_f32 v123, v134, v135
    v_mfma_f32_16x16x32_bf16 v[200:203], v[172:175], v[68:71], v[200:203]
    v_max3_f32 v250, v180, v181, v182
    v_max3_f32 v251, v183, v184, v185
    v_mfma_f32_16x16x32_bf16 v[192:195], v[144:147], v[92:95], v[192:195]
    v_max3_f32 v250, v250, v186, v187
    v_max3_f32 v251, v251, v188, v189
    v_mfma_f32_16x16x32_bf16 v[196:199], v[160:163], v[92:95], v[196:199]
    v_max3_f32 v250, v250, v190, v191
    v_max_f32 v250, v250, v251
    v_mfma_f32_16x16x32_bf16 v[200:203], v[176:179], v[92:95], v[200:203]
    v_mov_b32 v251, v250
    s_nop 1
    v_permlane32_swap_b32 v250, v251
    v_mfma_f32_16x16x32_bf16 v[192:195], v[148:151], v[116:119], v[192:195]
    v_max_f32 v250, v250, v251
    v_mov_b32 v251, v250
    v_mfma_f32_16x16x32_bf16 v[196:199], v[164:167], v[116:119], v[196:199]
    s_nop 0
    v_permlane16_swap_b32 v250, v251
    v_max_f32 v250, v250, v251
    v_mfma_f32_16x16x32_bf16 v[200:203], v[224:227], v[116:119], v[200:203]
    v_mul_f32 v250, s60, v250
    v_fma_f32 v180, v180, s60, -v250
    v_mfma_f32_16x16x32_bf16 v[204:207], v[136:139], v[48:51], 0
    v_fma_f32 v181, v181, s60, -v250
    v_fma_f32 v182, v182, s60, -v250
    v_mfma_f32_16x16x32_bf16 v[208:211], v[152:155], v[48:51], 0
    v_fma_f32 v183, v183, s60, -v250
    v_fma_f32 v184, v184, s60, -v250
    v_mfma_f32_16x16x32_bf16 v[212:215], v[168:171], v[48:51], 0
    v_fma_f32 v185, v185, s60, -v250
    v_fma_f32 v186, v186, s60, -v250
    v_mfma_f32_16x16x32_bf16 v[204:207], v[140:143], v[72:75], v[204:207]
    v_fma_f32 v187, v187, s60, -v250
    v_fma_f32 v188, v188, s60, -v250
    v_mfma_f32_16x16x32_bf16 v[208:211], v[156:159], v[72:75], v[208:211]
    v_fma_f32 v189, v189, s60, -v250
    v_fma_f32 v190, v190, s60, -v250
    v_mfma_f32_16x16x32_bf16 v[212:215], v[172:175], v[72:75], v[212:215]
    v_fma_f32 v191, v191, s60, -v250
    v_exp_f32 v180, v180
    v_mfma_f32_16x16x32_bf16 v[204:207], v[144:147], v[96:99], v[204:207]
    v_exp_f32 v181, v181
    v_exp_f32 v182, v182
    v_mfma_f32_16x16x32_bf16 v[208:211], v[160:163], v[96:99], v[208:211]
    v_exp_f32 v183, v183
    v_exp_f32 v184, v184
    v_mfma_f32_16x16x32_bf16 v[212:215], v[176:179], v[96:99], v[212:215]
    v_exp_f32 v185, v185
    v_exp_f32 v186, v186
    v_mfma_f32_16x16x32_bf16 v[204:207], v[148:151], v[120:123], v[204:207]
    v_exp_f32 v187, v187
    v_exp_f32 v188, v188
    v_mfma_f32_16x16x32_bf16 v[208:211], v[164:167], v[120:123], v[208:211]
    v_exp_f32 v189, v189
    v_exp_f32 v190, v190
    v_mfma_f32_16x16x32_bf16 v[212:215], v[224:227], v[120:123], v[212:215]
    v_exp_f32 v191, v191
    v_add_f32 v250, v180, v181
    v_add_f32 v251, v182, v183
    v_add_f32 v250, v250, v184
    v_add_f32 v251, v251, v185
    v_max3_f32 v252, v192, v193, v194
    v_add_f32 v250, v250, v186
    v_max3_f32 v253, v195, v196, v197
    v_add_f32 v251, v251, v187
    v_max3_f32 v252, v252, v198, v199
    v_add_f32 v250, v250, v188
    v_max3_f32 v253, v253, v200, v201
    v_add_f32 v251, v251, v189
    v_max3_f32 v252, v252, v202, v203
    v_add_f32 v250, v250, v190
    v_max_f32 v252, v252, v253
    v_add_f32 v251, v251, v191
    v_mov_b32 v253, v252
    v_add_f32 v250, v250, v251
    s_nop 0
    v_permlane32_swap_b32 v252, v253
    v_mov_b32 v251, v250
    v_max_f32 v252, v252, v253
    s_nop 0
    v_permlane32_swap_b32 v250, v251
    v_mov_b32 v253, v252
    v_add_f32 v250, v250, v251
    s_nop 0
    v_permlane16_swap_b32 v252, v253
    v_mov_b32 v251, v250
    v_max_f32 v252, v252, v253
    s_nop 0
    v_permlane16_swap_b32 v250, v251
    v_mul_f32 v252, s60, v252
    v_add_f32 v250, v250, v251
    v_fma_f32 v192, v192, s60, -v252
    v_rcp_f32 v250, v250
    v_fma_f32 v193, v193, s60, -v252
    v_mul_f32 v180, v180, v250
    v_fma_f32 v194, v194, s60, -v252
    v_mul_f32 v181, v181, v250
    v_fma_f32 v195, v195, s60, -v252
    v_mul_f32 v182, v182, v250
    v_fma_f32 v196, v196, s60, -v252
    v_mul_f32 v183, v183, v250
    v_fma_f32 v197, v197, s60, -v252
    v_mul_f32 v184, v184, v250
    v_fma_f32 v198, v198, s60, -v252
    v_mul_f32 v185, v185, v250
    v_fma_f32 v199, v199, s60, -v252
    v_mul_f32 v186, v186, v250
    v_fma_f32 v200, v200, s60, -v252
    v_mul_f32 v187, v187, v250
    v_fma_f32 v201, v201, s60, -v252
    v_mul_f32 v188, v188, v250
    v_fma_f32 v202, v202, s60, -v252
    v_mul_f32 v189, v189, v250
    v_fma_f32 v203, v203, s60, -v252
    v_mul_f32 v190, v190, v250
    v_exp_f32 v192, v192
    v_mul_f32 v191, v191, v250
    v_exp_f32 v193, v193
    v_cvt_pk_bf16_f32 v232, v180, v181
    v_exp_f32 v194, v194
    v_cvt_pk_bf16_f32 v233, v182, v183
    v_exp_f32 v195, v195
    v_cvt_pk_bf16_f32 v234, v184, v185
    v_exp_f32 v196, v196
    v_cvt_pk_bf16_f32 v235, v186, v187
    v_exp_f32 v197, v197
    v_cvt_pk_bf16_f32 v236, v188, v189
    v_exp_f32 v198, v198
    v_cvt_pk_bf16_f32 v237, v190, v191
    v_exp_f32 v199, v199
    s_barrier
    ds_read_b64_tr_b16 v[52:53], v8 offset:32768
    v_exp_f32 v200, v200
    v_max3_f32 v254, v204, v205, v206
    ds_read_b64_tr_b16 v[54:55], v8 offset:49152
    v_exp_f32 v201, v201
    v_max3_f32 v255, v207, v208, v209
    ds_read_b64_tr_b16 v[56:57], v9 offset:32768
    v_exp_f32 v202, v202
    v_max3_f32 v254, v254, v210, v211
    ds_read_b64_tr_b16 v[58:59], v9 offset:49152
    v_exp_f32 v203, v203
    v_max3_f32 v255, v255, v212, v213
    ds_read_b64_tr_b16 v[60:61], v10 offset:32768
    v_add_f32 v252, v192, v193
    v_max3_f32 v254, v254, v214, v215
    ds_read_b64_tr_b16 v[62:63], v10 offset:49152
    v_add_f32 v253, v194, v195
    v_max_f32 v254, v254, v255
    ds_read_b64_tr_b16 v[76:77], v11 offset:32768
    v_add_f32 v252, v252, v196
    v_mov_b32 v255, v254
    ds_read_b64_tr_b16 v[78:79], v11 offset:49152
    v_add_f32 v253, v253, v197
    v_permlane32_swap_b32 v254, v255
    ds_read_b64_tr_b16 v[80:81], v12 offset:32768
    v_add_f32 v252, v252, v198
    v_max_f32 v254, v254, v255
    ds_read_b64_tr_b16 v[82:83], v12 offset:49152
    v_add_f32 v253, v253, v199
    v_mov_b32 v255, v254
    ds_read_b64_tr_b16 v[84:85], v13 offset:32768
    v_add_f32 v252, v252, v200
    v_permlane16_swap_b32 v254, v255
    ds_read_b64_tr_b16 v[86:87], v13 offset:49152
    v_add_f32 v253, v253, v201
    v_max_f32 v254, v254, v255
    ds_read_b64_tr_b16 v[100:101], v14 offset:32768
    v_add_f32 v252, v252, v202
    v_mul_f32 v254, s60, v254
    ds_read_b64_tr_b16 v[102:103], v14 offset:49152
    v_add_f32 v253, v253, v203
    v_fma_f32 v204, v204, s60, -v254
    ds_read_b64_tr_b16 v[104:105], v15 offset:32768
    v_add_f32 v252, v252, v253
    v_fma_f32 v205, v205, s60, -v254
    ds_read_b64_tr_b16 v[106:107], v15 offset:49152
    v_mov_b32 v253, v252
    v_fma_f32 v206, v206, s60, -v254
    ds_read_b64_tr_b16 v[108:109], v8 offset:0
    v_permlane32_swap_b32 v252, v253
    v_fma_f32 v207, v207, s60, -v254
    ds_read_b64_tr_b16 v[110:111], v9 offset:0
    v_add_f32 v252, v252, v253
    v_fma_f32 v208, v208, s60, -v254
    ds_read_b64_tr_b16 v[124:125], v10 offset:0
    v_mov_b32 v253, v252
    v_fma_f32 v209, v209, s60, -v254
    ds_read_b64_tr_b16 v[126:127], v11 offset:0
    v_permlane16_swap_b32 v252, v253
    v_fma_f32 v210, v210, s60, -v254
    ds_read_b64_tr_b16 v[128:129], v12 offset:0
    v_add_f32 v252, v252, v253
    v_fma_f32 v211, v211, s60, -v254
    ds_read_b64_tr_b16 v[130:131], v13 offset:0
    v_rcp_f32 v252, v252
    v_fma_f32 v212, v212, s60, -v254
    ds_read_b64_tr_b16 v[132:133], v14 offset:0
    v_mul_f32 v192, v192, v252
    v_fma_f32 v213, v213, s60, -v254
    ds_read_b64_tr_b16 v[134:135], v15 offset:0
    v_mul_f32 v193, v193, v252
    v_fma_f32 v214, v214, s60, -v254
    s_waitcnt lgkmcnt(0)
    s_barrier
    v_mfma_f32_16x16x32_bf16 v[136:139], v[52:55], v[232:235], 0
    v_mul_f32 v194, v194, v252
    v_fma_f32 v215, v215, s60, -v254
    v_mfma_f32_16x16x32_bf16 v[140:143], v[56:59], v[232:235], 0
    v_mul_f32 v195, v195, v252
    v_exp_f32 v204, v204
    v_mfma_f32_16x16x32_bf16 v[144:147], v[60:63], v[232:235], 0
    v_mul_f32 v196, v196, v252
    v_exp_f32 v205, v205
    v_mfma_f32_16x16x32_bf16 v[148:151], v[76:79], v[232:235], 0
    v_mul_f32 v197, v197, v252
    v_exp_f32 v206, v206
    v_mfma_f32_16x16x32_bf16 v[152:155], v[80:83], v[232:235], 0
    v_mul_f32 v198, v198, v252
    v_exp_f32 v207, v207
    v_mfma_f32_16x16x32_bf16 v[156:159], v[84:87], v[232:235], 0
    v_mul_f32 v199, v199, v252
    v_exp_f32 v208, v208
    v_mfma_f32_16x16x32_bf16 v[160:163], v[100:103], v[232:235], 0
    v_mul_f32 v200, v200, v252
    v_exp_f32 v209, v209
    v_mfma_f32_16x16x32_bf16 v[164:167], v[104:107], v[232:235], 0
    v_mul_f32 v201, v201, v252
    v_exp_f32 v210, v210
    v_mfma_f32_16x16x16_bf16 v[136:139], v[108:109], v[236:237], v[136:139]
    v_mul_f32 v202, v202, v252
    v_exp_f32 v211, v211
    v_mfma_f32_16x16x16_bf16 v[140:143], v[110:111], v[236:237], v[140:143]
    v_mul_f32 v203, v203, v252
    v_exp_f32 v212, v212
    v_mfma_f32_16x16x16_bf16 v[144:147], v[124:125], v[236:237], v[144:147]
    v_cvt_pk_bf16_f32 v238, v192, v193
    v_exp_f32 v213, v213
    v_mfma_f32_16x16x16_bf16 v[148:151], v[126:127], v[236:237], v[148:151]
    v_cvt_pk_bf16_f32 v239, v194, v195
    v_exp_f32 v214, v214
    v_mfma_f32_16x16x16_bf16 v[152:155], v[128:129], v[236:237], v[152:155]
    v_cvt_pk_bf16_f32 v240, v196, v197
    v_exp_f32 v215, v215
    v_mfma_f32_16x16x16_bf16 v[156:159], v[130:131], v[236:237], v[156:159]
    v_cvt_pk_bf16_f32 v241, v198, v199
    v_add_f32 v254, v204, v205
    v_mfma_f32_16x16x16_bf16 v[160:163], v[132:133], v[236:237], v[160:163]
    v_cvt_pk_bf16_f32 v242, v200, v201
    v_add_f32 v255, v206, v207
    v_mfma_f32_16x16x16_bf16 v[164:167], v[134:135], v[236:237], v[164:167]
    v_cvt_pk_bf16_f32 v243, v202, v203
    v_add_f32 v254, v254, v208
    s_cmp_eq_u32 s57, 1
    s_cbranch_scc1 GIVER
    v_mfma_f32_16x16x32_bf16 v[168:171], v[52:55], v[238:241], 0
    v_add_f32 v255, v255, v209
    v_cvt_pk_bf16_f32 v40, v136, v137
    v_mfma_f32_16x16x32_bf16 v[172:175], v[56:59], v[238:241], 0
    v_add_f32 v254, v254, v210
    v_cvt_pk_bf16_f32 v41, v138, v139
    v_mfma_f32_16x16x32_bf16 v[176:179], v[60:63], v[238:241], 0
    v_add_f32 v255, v255, v211
    v_cvt_pk_bf16_f32 v42, v140, v141
    v_mfma_f32_16x16x32_bf16 v[224:227], v[76:79], v[238:241], 0
    v_add_f32 v254, v254, v212
    v_cvt_pk_bf16_f32 v43, v142, v143
    v_mfma_f32_16x16x32_bf16 v[180:183], v[80:83], v[238:241], 0
    v_add_f32 v255, v255, v213
    ds_write_b128 v28, v[40:43] offset:0
    v_mfma_f32_16x16x32_bf16 v[184:187], v[84:87], v[238:241], 0
    v_add_f32 v254, v254, v214
    v_cvt_pk_bf16_f32 v64, v144, v145
    v_mfma_f32_16x16x32_bf16 v[188:191], v[100:103], v[238:241], 0
    v_add_f32 v255, v255, v215
    v_cvt_pk_bf16_f32 v65, v146, v147
    v_mfma_f32_16x16x32_bf16 v[216:219], v[104:107], v[238:241], 0
    v_add_f32 v254, v254, v255
    v_cvt_pk_bf16_f32 v66, v148, v149
    v_mfma_f32_16x16x16_bf16 v[168:171], v[108:109], v[242:243], v[168:171]
    v_mov_b32 v255, v254
    v_cvt_pk_bf16_f32 v67, v150, v151
    v_mfma_f32_16x16x16_bf16 v[172:175], v[110:111], v[242:243], v[172:175]
    v_permlane32_swap_b32 v254, v255
    ds_write_b128 v28, v[64:67] offset:1024
    v_mfma_f32_16x16x16_bf16 v[176:179], v[124:125], v[242:243], v[176:179]
    v_add_f32 v254, v254, v255
    v_cvt_pk_bf16_f32 v88, v152, v153
    v_mfma_f32_16x16x16_bf16 v[224:227], v[126:127], v[242:243], v[224:227]
    v_mov_b32 v255, v254
    v_cvt_pk_bf16_f32 v89, v154, v155
    v_mfma_f32_16x16x16_bf16 v[180:183], v[128:129], v[242:243], v[180:183]
    v_permlane16_swap_b32 v254, v255
    v_cvt_pk_bf16_f32 v90, v156, v157
    v_mfma_f32_16x16x16_bf16 v[184:187], v[130:131], v[242:243], v[184:187]
    v_add_f32 v254, v254, v255
    v_cvt_pk_bf16_f32 v91, v158, v159
    v_mfma_f32_16x16x16_bf16 v[188:191], v[132:133], v[242:243], v[188:191]
    v_rcp_f32 v254, v254
    ds_write_b128 v28, v[88:91] offset:2048
    v_mfma_f32_16x16x16_bf16 v[216:219], v[134:135], v[242:243], v[216:219]
    v_mul_f32 v204, v204, v254
    v_cvt_pk_bf16_f32 v112, v160, v161
    v_mul_f32 v205, v205, v254
    v_cvt_pk_bf16_f32 v113, v162, v163
    v_mul_f32 v206, v206, v254
    v_cvt_pk_bf16_f32 v114, v164, v165
    v_mul_f32 v207, v207, v254
    v_cvt_pk_bf16_f32 v115, v166, v167
    v_mul_f32 v208, v208, v254
    ds_write_b128 v28, v[112:115] offset:3072
    v_mul_f32 v209, v209, v254
    v_mul_f32 v210, v210, v254
    v_mul_f32 v211, v211, v254
    v_mul_f32 v212, v212, v254
    v_mul_f32 v213, v213, v254
    v_mul_f32 v214, v214, v254
    v_mul_f32 v215, v215, v254
    v_cvt_pk_bf16_f32 v244, v204, v205
    v_cvt_pk_bf16_f32 v245, v206, v207
    v_cvt_pk_bf16_f32 v246, v208, v209
    v_cvt_pk_bf16_f32 v247, v210, v211
    v_cvt_pk_bf16_f32 v248, v212, v213
    v_cvt_pk_bf16_f32 v249, v214, v215
    v_mfma_f32_16x16x32_bf16 v[136:139], v[52:55], v[244:247], 0
    v_cvt_pk_bf16_f32 v44, v168, v169
    v_mfma_f32_16x16x32_bf16 v[140:143], v[56:59], v[244:247], 0
    v_cvt_pk_bf16_f32 v45, v170, v171
    v_mfma_f32_16x16x32_bf16 v[144:147], v[60:63], v[244:247], 0
    v_cvt_pk_bf16_f32 v46, v172, v173
    v_mfma_f32_16x16x32_bf16 v[148:151], v[76:79], v[244:247], 0
    v_cvt_pk_bf16_f32 v47, v174, v175
    ds_write_b128 v28, v[44:47] offset:4096
    v_mfma_f32_16x16x32_bf16 v[152:155], v[80:83], v[244:247], 0
    v_cvt_pk_bf16_f32 v68, v176, v177
    v_mfma_f32_16x16x32_bf16 v[156:159], v[84:87], v[244:247], 0
    v_cvt_pk_bf16_f32 v69, v178, v179
    v_mfma_f32_16x16x32_bf16 v[160:163], v[100:103], v[244:247], 0
    v_cvt_pk_bf16_f32 v70, v224, v225
    v_mfma_f32_16x16x32_bf16 v[164:167], v[104:107], v[244:247], 0
    v_cvt_pk_bf16_f32 v71, v226, v227
    ds_write_b128 v28, v[68:71] offset:5120
    v_mfma_f32_16x16x16_bf16 v[136:139], v[108:109], v[248:249], v[136:139]
    v_cvt_pk_bf16_f32 v92, v180, v181
    v_mfma_f32_16x16x16_bf16 v[140:143], v[110:111], v[248:249], v[140:143]
    v_cvt_pk_bf16_f32 v93, v182, v183
    v_mfma_f32_16x16x16_bf16 v[144:147], v[124:125], v[248:249], v[144:147]
    v_cvt_pk_bf16_f32 v94, v184, v185
    v_mfma_f32_16x16x16_bf16 v[148:151], v[126:127], v[248:249], v[148:151]
    v_cvt_pk_bf16_f32 v95, v186, v187
    ds_write_b128 v28, v[92:95] offset:6144
    v_mfma_f32_16x16x16_bf16 v[152:155], v[128:129], v[248:249], v[152:155]
    v_cvt_pk_bf16_f32 v116, v188, v189
    v_mfma_f32_16x16x16_bf16 v[156:159], v[130:131], v[248:249], v[156:159]
    v_cvt_pk_bf16_f32 v117, v190, v191
    v_mfma_f32_16x16x16_bf16 v[160:163], v[132:133], v[248:249], v[160:163]
    v_cvt_pk_bf16_f32 v118, v216, v217
    v_mfma_f32_16x16x16_bf16 v[164:167], v[134:135], v[248:249], v[164:167]
    v_cvt_pk_bf16_f32 v119, v218, v219
    ds_write_b128 v28, v[116:119] offset:7168
    v_cvt_pk_bf16_f32 v48, v136, v137
    v_cvt_pk_bf16_f32 v49, v138, v139
    v_cvt_pk_bf16_f32 v50, v140, v141
    v_cvt_pk_bf16_f32 v51, v142, v143
    ds_write_b128 v28, v[48:51] offset:8192
    v_cvt_pk_bf16_f32 v72, v144, v145
    v_cvt_pk_bf16_f32 v73, v146, v147
    v_cvt_pk_bf16_f32 v74, v148, v149
    v_cvt_pk_bf16_f32 v75, v150, v151
    ds_write_b128 v28, v[72:75] offset:9216
    v_cvt_pk_bf16_f32 v96, v152, v153
    v_cvt_pk_bf16_f32 v97, v154, v155
    v_cvt_pk_bf16_f32 v98, v156, v157
    v_cvt_pk_bf16_f32 v99, v158, v159
    ds_write_b128 v28, v[96:99] offset:10240
    v_cvt_pk_bf16_f32 v120, v160, v161
    v_cvt_pk_bf16_f32 v121, v162, v163
    v_cvt_pk_bf16_f32 v122, v164, v165
    v_cvt_pk_bf16_f32 v123, v166, v167
    ds_write_b128 v28, v[120:123] offset:11264
    s_waitcnt lgkmcnt(0)
    s_branch ATT_END
GIVER:
    v_mfma_f32_16x16x32_bf16 v[168:171], v[52:55], v[238:241], 0
    v_add_f32 v255, v255, v209
    v_cvt_pk_bf16_f32 v40, v136, v137
    v_mfma_f32_16x16x32_bf16 v[172:175], v[56:59], v[238:241], 0
    v_add_f32 v254, v254, v210
    v_cvt_pk_bf16_f32 v41, v138, v139
    v_mfma_f32_16x16x32_bf16 v[176:179], v[60:63], v[238:241], 0
    v_add_f32 v255, v255, v211
    v_cvt_pk_bf16_f32 v42, v140, v141
    v_mfma_f32_16x16x32_bf16 v[224:227], v[76:79], v[238:241], 0
    v_add_f32 v254, v254, v212
    v_cvt_pk_bf16_f32 v43, v142, v143
    v_mfma_f32_16x16x32_bf16 v[180:183], v[80:83], v[238:241], 0
    v_add_f32 v255, v255, v213
    v_cvt_pk_bf16_f32 v64, v144, v145
    v_mfma_f32_16x16x32_bf16 v[184:187], v[84:87], v[238:241], 0
    v_add_f32 v254, v254, v214
    v_cvt_pk_bf16_f32 v65, v146, v147
    v_mfma_f32_16x16x32_bf16 v[188:191], v[100:103], v[238:241], 0
    v_add_f32 v255, v255, v215
    v_cvt_pk_bf16_f32 v66, v148, v149
    v_mfma_f32_16x16x32_bf16 v[216:219], v[104:107], v[238:241], 0
    v_add_f32 v254, v254, v255
    v_cvt_pk_bf16_f32 v67, v150, v151
    v_mfma_f32_16x16x16_bf16 v[168:171], v[108:109], v[242:243], v[168:171]
    v_mov_b32 v255, v254
    v_cvt_pk_bf16_f32 v88, v152, v153
    v_mfma_f32_16x16x16_bf16 v[172:175], v[110:111], v[242:243], v[172:175]
    v_permlane32_swap_b32 v254, v255
    v_cvt_pk_bf16_f32 v89, v154, v155
    v_mfma_f32_16x16x16_bf16 v[176:179], v[124:125], v[242:243], v[176:179]
    v_add_f32 v254, v254, v255
    v_cvt_pk_bf16_f32 v90, v156, v157
    v_mfma_f32_16x16x16_bf16 v[224:227], v[126:127], v[242:243], v[224:227]
    v_mov_b32 v255, v254
    v_cvt_pk_bf16_f32 v91, v158, v159
    v_mfma_f32_16x16x16_bf16 v[180:183], v[128:129], v[242:243], v[180:183]
    v_permlane16_swap_b32 v254, v255
    v_cvt_pk_bf16_f32 v112, v160, v161
    v_mfma_f32_16x16x16_bf16 v[184:187], v[130:131], v[242:243], v[184:187]
    v_add_f32 v254, v254, v255
    v_cvt_pk_bf16_f32 v113, v162, v163
    v_mfma_f32_16x16x16_bf16 v[188:191], v[132:133], v[242:243], v[188:191]
    v_rcp_f32 v254, v254
    v_cvt_pk_bf16_f32 v114, v164, v165
    v_mfma_f32_16x16x16_bf16 v[216:219], v[134:135], v[242:243], v[216:219]
    v_mul_f32 v204, v204, v254
    v_cvt_pk_bf16_f32 v115, v166, v167
    v_mul_f32 v205, v205, v254
    v_mul_f32 v206, v206, v254
    v_mul_f32 v207, v207, v254
    v_mul_f32 v208, v208, v254
    v_mul_f32 v209, v209, v254
    v_mul_f32 v210, v210, v254
    v_mul_f32 v211, v211, v254
    v_mul_f32 v212, v212, v254
    v_mul_f32 v213, v213, v254
    v_mul_f32 v214, v214, v254
    v_mul_f32 v215, v215, v254
    v_cvt_pk_bf16_f32 v244, v204, v205
    v_cvt_pk_bf16_f32 v245, v206, v207
    v_cvt_pk_bf16_f32 v246, v208, v209
    v_cvt_pk_bf16_f32 v247, v210, v211
    v_cvt_pk_bf16_f32 v248, v212, v213
    v_cvt_pk_bf16_f32 v249, v214, v215
    v_mfma_f32_16x16x32_bf16 v[136:139], v[52:55], v[244:247], 0
    buffer_store_dwordx4 v[40:43], v3, s[4:7], 0 offen offset:0 sc0 sc1
    v_mfma_f32_16x16x32_bf16 v[140:143], v[56:59], v[244:247], 0
    buffer_store_dwordx4 v[64:67], v3, s[4:7], 0 offen offset:1024 sc0 sc1
    v_mfma_f32_16x16x32_bf16 v[144:147], v[60:63], v[244:247], 0
    buffer_store_dwordx4 v[88:91], v3, s[4:7], 0 offen offset:2048 sc0 sc1
    v_mfma_f32_16x16x32_bf16 v[148:151], v[76:79], v[244:247], 0
    buffer_store_dwordx4 v[112:115], v3, s[4:7], 0 offen offset:3072 sc0 sc1
    v_cvt_pk_bf16_f32 v44, v168, v169
    v_mfma_f32_16x16x32_bf16 v[152:155], v[80:83], v[244:247], 0
    v_cvt_pk_bf16_f32 v45, v170, v171
    v_mfma_f32_16x16x32_bf16 v[156:159], v[84:87], v[244:247], 0
    v_cvt_pk_bf16_f32 v46, v172, v173
    v_mfma_f32_16x16x32_bf16 v[160:163], v[100:103], v[244:247], 0
    v_cvt_pk_bf16_f32 v47, v174, v175
    v_mfma_f32_16x16x32_bf16 v[164:167], v[104:107], v[244:247], 0
    v_cvt_pk_bf16_f32 v68, v176, v177
    v_cvt_pk_bf16_f32 v69, v178, v179
    v_mfma_f32_16x16x16_bf16 v[136:139], v[108:109], v[248:249], v[136:139]
    v_cvt_pk_bf16_f32 v70, v224, v225
    v_mfma_f32_16x16x16_bf16 v[140:143], v[110:111], v[248:249], v[140:143]
    v_cvt_pk_bf16_f32 v71, v226, v227
    v_mfma_f32_16x16x16_bf16 v[144:147], v[124:125], v[248:249], v[144:147]
    v_cvt_pk_bf16_f32 v92, v180, v181
    v_mfma_f32_16x16x16_bf16 v[148:151], v[126:127], v[248:249], v[148:151]
    v_cvt_pk_bf16_f32 v93, v182, v183
    v_cvt_pk_bf16_f32 v94, v184, v185
    v_mfma_f32_16x16x16_bf16 v[152:155], v[128:129], v[248:249], v[152:155]
    v_cvt_pk_bf16_f32 v95, v186, v187
    v_mfma_f32_16x16x16_bf16 v[156:159], v[130:131], v[248:249], v[156:159]
    v_cvt_pk_bf16_f32 v116, v188, v189
    v_mfma_f32_16x16x16_bf16 v[160:163], v[132:133], v[248:249], v[160:163]
    v_cvt_pk_bf16_f32 v117, v190, v191
    v_mfma_f32_16x16x16_bf16 v[164:167], v[134:135], v[248:249], v[164:167]
    v_cvt_pk_bf16_f32 v118, v216, v217
    v_cvt_pk_bf16_f32 v119, v218, v219
    buffer_store_dwordx4 v[44:47], v3, s[4:7], s27 offen offset:0 sc0 sc1
    buffer_store_dwordx4 v[68:71], v3, s[4:7], s27 offen offset:1024 sc0 sc1
    buffer_store_dwordx4 v[92:95], v3, s[4:7], s27 offen offset:2048 sc0 sc1
    buffer_store_dwordx4 v[116:119], v3, s[4:7], s27 offen offset:3072 sc0 sc1
    v_cvt_pk_bf16_f32 v48, v136, v137
    v_cvt_pk_bf16_f32 v49, v138, v139
    v_cvt_pk_bf16_f32 v50, v140, v141
    v_cvt_pk_bf16_f32 v51, v142, v143
    v_cvt_pk_bf16_f32 v72, v144, v145
    v_cvt_pk_bf16_f32 v73, v146, v147
    v_cvt_pk_bf16_f32 v74, v148, v149
    v_cvt_pk_bf16_f32 v75, v150, v151
    v_cvt_pk_bf16_f32 v96, v152, v153
    v_cvt_pk_bf16_f32 v97, v154, v155
    v_cvt_pk_bf16_f32 v98, v156, v157
    v_cvt_pk_bf16_f32 v99, v158, v159
    v_cvt_pk_bf16_f32 v120, v160, v161
    v_cvt_pk_bf16_f32 v121, v162, v163
    v_cvt_pk_bf16_f32 v122, v164, v165
    v_cvt_pk_bf16_f32 v123, v166, v167
ATT_END:
    s_barrier
    ds_read_b64_tr_b16 v[8:9], v4 offset:0
    ds_read_b64_tr_b16 v[10:11], v4 offset:2048
    ds_read_b128 v[160:163], v2 offset:0
    ds_read_b128 v[164:167], v2 offset:4096
    ds_read_b128 v[168:171], v2 offset:8192
    ds_read_b64_tr_b16 v[12:13], v4 offset:4096
    ds_read_b64_tr_b16 v[14:15], v4 offset:6144
    ds_read_b128 v[172:175], v2 offset:1024
    ds_read_b128 v[176:179], v2 offset:5120
    ds_read_b128 v[180:183], v2 offset:9216
    ds_read_b64_tr_b16 v[16:17], v4 offset:8192
    ds_read_b64_tr_b16 v[18:19], v4 offset:10240
    ds_read_b128 v[184:187], v2 offset:2048
    ds_read_b128 v[188:191], v2 offset:6144
    ds_read_b128 v[192:195], v2 offset:10240
    ds_read_b64_tr_b16 v[20:21], v4 offset:12288
    ds_read_b64_tr_b16 v[22:23], v4 offset:14336
    ds_read_b128 v[196:199], v2 offset:3072
    ds_read_b128 v[200:203], v2 offset:7168
    ds_read_b128 v[204:207], v2 offset:11264
    s_waitcnt lgkmcnt(15)
    v_mfma_f32_16x16x32_bf16 v[28:31], v[8:11], v[160:163], 0
    ds_read_b64_tr_b16 v[24:25], v4 offset:16384
    ds_read_b64_tr_b16 v[26:27], v4 offset:18432
    buffer_store_dwordx4 v[48:51], v3, s[4:7], s28 offen offset:0 sc0 sc1
    v_mfma_f32_16x16x32_bf16 v[32:35], v[8:11], v[164:167], 0
    ds_read_b128 v[208:211], v2 offset:12288
    ds_read_b128 v[212:215], v2 offset:16384
    buffer_store_dwordx4 v[72:75], v3, s[4:7], s28 offen offset:1024 sc0 sc1
    v_mfma_f32_16x16x32_bf16 v[36:39], v[8:11], v[168:171], 0
    ds_read_b128 v[216:219], v2 offset:20480
    buffer_store_dwordx4 v[96:99], v3, s[4:7], s28 offen offset:2048 sc0 sc1
    s_waitcnt lgkmcnt(15)
    v_mfma_f32_16x16x32_bf16 v[28:31], v[12:15], v[172:175], v[28:31]
    ds_read_b64_tr_b16 v[8:9], v4 offset:20480
    ds_read_b64_tr_b16 v[10:11], v4 offset:22528
    buffer_store_dwordx4 v[120:123], v3, s[4:7], s28 offen offset:3072 sc0 sc1
    v_mfma_f32_16x16x32_bf16 v[32:35], v[12:15], v[176:179], v[32:35]
    ds_read_b128 v[220:223], v2 offset:13312
    ds_read_b128 v[224:227], v2 offset:17408
    v_mfma_f32_16x16x32_bf16 v[36:39], v[12:15], v[180:183], v[36:39]
    ds_read_b128 v[228:231], v2 offset:21504
    s_waitcnt lgkmcnt(15)
    v_mfma_f32_16x16x32_bf16 v[28:31], v[16:19], v[184:187], v[28:31]
    ds_read_b64_tr_b16 v[12:13], v4 offset:24576
    ds_read_b64_tr_b16 v[14:15], v4 offset:26624
    v_mfma_f32_16x16x32_bf16 v[32:35], v[16:19], v[188:191], v[32:35]
    ds_read_b128 v[232:235], v2 offset:14336
    ds_read_b128 v[236:239], v2 offset:18432
    v_mfma_f32_16x16x32_bf16 v[36:39], v[16:19], v[192:195], v[36:39]
    ds_read_b128 v[240:243], v2 offset:22528
    s_waitcnt lgkmcnt(15)
    v_mfma_f32_16x16x32_bf16 v[28:31], v[20:23], v[196:199], v[28:31]
    ds_read_b64_tr_b16 v[16:17], v4 offset:28672
    ds_read_b64_tr_b16 v[18:19], v4 offset:30720
    v_mfma_f32_16x16x32_bf16 v[32:35], v[20:23], v[200:203], v[32:35]
    ds_read_b128 v[244:247], v2 offset:15360
    ds_read_b128 v[248:251], v2 offset:19456
    v_mfma_f32_16x16x32_bf16 v[36:39], v[20:23], v[204:207], v[36:39]
    ds_read_b128 v[252:255], v2 offset:23552
    s_waitcnt lgkmcnt(3)
    s_barrier
    v_add_u32 v4, 0xffff8000, v4
    v_mfma_f32_16x16x32_bf16 v[28:31], v[24:27], v[208:211], v[28:31]
    ds_read_b64_tr_b16 v[20:21], v4 offset:0
    v_mfma_f32_16x16x32_bf16 v[32:35], v[24:27], v[212:215], v[32:35]
    ds_read_b64_tr_b16 v[22:23], v4 offset:2048
    v_mfma_f32_16x16x32_bf16 v[36:39], v[24:27], v[216:219], v[36:39]
    v_mfma_f32_16x16x32_bf16 v[28:31], v[8:11], v[220:223], v[28:31]
    ds_read_b64_tr_b16 v[24:25], v4 offset:4096
    v_mfma_f32_16x16x32_bf16 v[32:35], v[8:11], v[224:227], v[32:35]
    ds_read_b64_tr_b16 v[26:27], v4 offset:6144
    v_mfma_f32_16x16x32_bf16 v[36:39], v[8:11], v[228:231], v[36:39]
    v_mfma_f32_16x16x32_bf16 v[28:31], v[12:15], v[232:235], v[28:31]
    ds_read_b64_tr_b16 v[8:9], v4 offset:8192
    v_mfma_f32_16x16x32_bf16 v[32:35], v[12:15], v[236:239], v[32:35]
    ds_read_b64_tr_b16 v[10:11], v4 offset:10240
    v_mfma_f32_16x16x32_bf16 v[36:39], v[12:15], v[240:243], v[36:39]
    s_waitcnt lgkmcnt(6)
    v_mfma_f32_16x16x32_bf16 v[28:31], v[16:19], v[244:247], v[28:31]
    ds_read_b64_tr_b16 v[12:13], v4 offset:12288
    v_mfma_f32_16x16x32_bf16 v[32:35], v[16:19], v[248:251], v[32:35]
    ds_read_b64_tr_b16 v[14:15], v4 offset:14336
    v_mfma_f32_16x16x32_bf16 v[36:39], v[16:19], v[252:255], v[36:39]
    s_waitcnt lgkmcnt(6)
    v_mfma_f32_16x16x32_bf16 v[52:55], v[20:23], v[160:163], 0
    ds_read_b64_tr_b16 v[16:17], v4 offset:16384
    v_mfma_f32_16x16x32_bf16 v[56:59], v[20:23], v[164:167], 0
    ds_read_b64_tr_b16 v[18:19], v4 offset:18432
    v_mfma_f32_16x16x32_bf16 v[60:63], v[20:23], v[168:171], 0
    s_waitcnt lgkmcnt(6)
    v_mfma_f32_16x16x32_bf16 v[52:55], v[24:27], v[172:175], v[52:55]
    ds_read_b64_tr_b16 v[20:21], v4 offset:20480
    v_mfma_f32_16x16x32_bf16 v[56:59], v[24:27], v[176:179], v[56:59]
    ds_read_b64_tr_b16 v[22:23], v4 offset:22528
    v_mfma_f32_16x16x32_bf16 v[60:63], v[24:27], v[180:183], v[60:63]
    s_waitcnt lgkmcnt(6)
    v_mfma_f32_16x16x32_bf16 v[52:55], v[8:11], v[184:187], v[52:55]
    ds_read_b64_tr_b16 v[24:25], v4 offset:24576
    v_mfma_f32_16x16x32_bf16 v[56:59], v[8:11], v[188:191], v[56:59]
    ds_read_b64_tr_b16 v[26:27], v4 offset:26624
    v_mfma_f32_16x16x32_bf16 v[60:63], v[8:11], v[192:195], v[60:63]
    s_waitcnt lgkmcnt(6)
    v_mfma_f32_16x16x32_bf16 v[52:55], v[12:15], v[196:199], v[52:55]
    ds_read_b64_tr_b16 v[8:9], v4 offset:28672
    v_mfma_f32_16x16x32_bf16 v[56:59], v[12:15], v[200:203], v[56:59]
    ds_read_b64_tr_b16 v[10:11], v4 offset:30720
    v_mfma_f32_16x16x32_bf16 v[60:63], v[12:15], v[204:207], v[60:63]
    s_waitcnt lgkmcnt(0)
    s_waitcnt vmcnt(0)
    s_barrier
    v_add_u32 v4, 0x10000, v4
    v_mfma_f32_16x16x32_bf16 v[52:55], v[16:19], v[208:211], v[52:55]
    ds_read_b64_tr_b16 v[12:13], v4 offset:0
    v_mfma_f32_16x16x32_bf16 v[56:59], v[16:19], v[212:215], v[56:59]
    ds_read_b64_tr_b16 v[14:15], v4 offset:2048
    v_mfma_f32_16x16x32_bf16 v[60:63], v[16:19], v[216:219], v[60:63]
    v_mfma_f32_16x16x32_bf16 v[52:55], v[20:23], v[220:223], v[52:55]
    ds_read_b64_tr_b16 v[16:17], v4 offset:4096
    v_mfma_f32_16x16x32_bf16 v[56:59], v[20:23], v[224:227], v[56:59]
    ds_read_b64_tr_b16 v[18:19], v4 offset:6144
    v_mfma_f32_16x16x32_bf16 v[60:63], v[20:23], v[228:231], v[60:63]
    v_mfma_f32_16x16x32_bf16 v[52:55], v[24:27], v[232:235], v[52:55]
    ds_read_b64_tr_b16 v[20:21], v4 offset:8192
    v_mfma_f32_16x16x32_bf16 v[56:59], v[24:27], v[236:239], v[56:59]
    ds_read_b64_tr_b16 v[22:23], v4 offset:10240
    v_mfma_f32_16x16x32_bf16 v[60:63], v[24:27], v[240:243], v[60:63]
    v_mfma_f32_16x16x32_bf16 v[52:55], v[8:11], v[244:247], v[52:55]
    ds_read_b64_tr_b16 v[24:25], v4 offset:12288
    v_mfma_f32_16x16x32_bf16 v[56:59], v[8:11], v[248:251], v[56:59]
    ds_read_b64_tr_b16 v[26:27], v4 offset:14336
    v_mfma_f32_16x16x32_bf16 v[60:63], v[8:11], v[252:255], v[60:63]
    s_waitcnt lgkmcnt(6)
    v_mfma_f32_16x16x32_bf16 v[76:79], v[12:15], v[160:163], 0
    ds_read_b64_tr_b16 v[8:9], v4 offset:16384
    v_mfma_f32_16x16x32_bf16 v[80:83], v[12:15], v[164:167], 0
    ds_read_b64_tr_b16 v[10:11], v4 offset:18432
    v_mfma_f32_16x16x32_bf16 v[84:87], v[12:15], v[168:171], 0
    s_waitcnt lgkmcnt(6)
    v_mfma_f32_16x16x32_bf16 v[76:79], v[16:19], v[172:175], v[76:79]
    ds_read_b64_tr_b16 v[12:13], v4 offset:20480
    v_mfma_f32_16x16x32_bf16 v[80:83], v[16:19], v[176:179], v[80:83]
    ds_read_b64_tr_b16 v[14:15], v4 offset:22528
    v_mfma_f32_16x16x32_bf16 v[84:87], v[16:19], v[180:183], v[84:87]
    s_waitcnt lgkmcnt(6)
    v_mfma_f32_16x16x32_bf16 v[76:79], v[20:23], v[184:187], v[76:79]
    ds_read_b64_tr_b16 v[16:17], v4 offset:24576
    v_mfma_f32_16x16x32_bf16 v[80:83], v[20:23], v[188:191], v[80:83]
    ds_read_b64_tr_b16 v[18:19], v4 offset:26624
    v_mfma_f32_16x16x32_bf16 v[84:87], v[20:23], v[192:195], v[84:87]
    s_waitcnt lgkmcnt(6)
    v_mfma_f32_16x16x32_bf16 v[76:79], v[24:27], v[196:199], v[76:79]
    ds_read_b64_tr_b16 v[20:21], v4 offset:28672
    v_mfma_f32_16x16x32_bf16 v[80:83], v[24:27], v[200:203], v[80:83]
    ds_read_b64_tr_b16 v[22:23], v4 offset:30720
    v_mfma_f32_16x16x32_bf16 v[84:87], v[24:27], v[204:207], v[84:87]
    s_waitcnt lgkmcnt(0)
    s_barrier
    v_add_u32 v4, 0x8000, v4
    v_mfma_f32_16x16x32_bf16 v[76:79], v[8:11], v[208:211], v[76:79]
    ds_read_b64_tr_b16 v[24:25], v4 offset:0
    v_mfma_f32_16x16x32_bf16 v[80:83], v[8:11], v[212:215], v[80:83]
    ds_read_b64_tr_b16 v[26:27], v4 offset:2048
    v_mfma_f32_16x16x32_bf16 v[84:87], v[8:11], v[216:219], v[84:87]
    v_mfma_f32_16x16x32_bf16 v[76:79], v[12:15], v[220:223], v[76:79]
    ds_read_b64_tr_b16 v[8:9], v4 offset:4096
    v_mfma_f32_16x16x32_bf16 v[80:83], v[12:15], v[224:227], v[80:83]
    ds_read_b64_tr_b16 v[10:11], v4 offset:6144
    v_mfma_f32_16x16x32_bf16 v[84:87], v[12:15], v[228:231], v[84:87]
    v_mfma_f32_16x16x32_bf16 v[76:79], v[16:19], v[232:235], v[76:79]
    ds_read_b64_tr_b16 v[12:13], v4 offset:8192
    v_mfma_f32_16x16x32_bf16 v[80:83], v[16:19], v[236:239], v[80:83]
    ds_read_b64_tr_b16 v[14:15], v4 offset:10240
    v_mfma_f32_16x16x32_bf16 v[84:87], v[16:19], v[240:243], v[84:87]
    v_mfma_f32_16x16x32_bf16 v[76:79], v[20:23], v[244:247], v[76:79]
    ds_read_b64_tr_b16 v[16:17], v4 offset:12288
    v_mfma_f32_16x16x32_bf16 v[80:83], v[20:23], v[248:251], v[80:83]
    ds_read_b64_tr_b16 v[18:19], v4 offset:14336
    v_mfma_f32_16x16x32_bf16 v[84:87], v[20:23], v[252:255], v[84:87]
    s_waitcnt lgkmcnt(6)
    v_mfma_f32_16x16x32_bf16 v[100:103], v[24:27], v[160:163], 0
    ds_read_b64_tr_b16 v[20:21], v4 offset:16384
    v_mfma_f32_16x16x32_bf16 v[104:107], v[24:27], v[164:167], 0
    ds_read_b64_tr_b16 v[22:23], v4 offset:18432
    v_mfma_f32_16x16x32_bf16 v[108:111], v[24:27], v[168:171], 0
    s_waitcnt lgkmcnt(6)
    v_mfma_f32_16x16x32_bf16 v[100:103], v[8:11], v[172:175], v[100:103]
    ds_read_b64_tr_b16 v[24:25], v4 offset:20480
    v_mfma_f32_16x16x32_bf16 v[104:107], v[8:11], v[176:179], v[104:107]
    ds_read_b64_tr_b16 v[26:27], v4 offset:22528
    v_mfma_f32_16x16x32_bf16 v[108:111], v[8:11], v[180:183], v[108:111]
    s_waitcnt lgkmcnt(6)
    v_mfma_f32_16x16x32_bf16 v[100:103], v[12:15], v[184:187], v[100:103]
    ds_read_b64_tr_b16 v[8:9], v4 offset:24576
    v_mfma_f32_16x16x32_bf16 v[104:107], v[12:15], v[188:191], v[104:107]
    ds_read_b64_tr_b16 v[10:11], v4 offset:26624
    v_mfma_f32_16x16x32_bf16 v[108:111], v[12:15], v[192:195], v[108:111]
    s_waitcnt lgkmcnt(6)
    v_mfma_f32_16x16x32_bf16 v[100:103], v[16:19], v[196:199], v[100:103]
    ds_read_b64_tr_b16 v[12:13], v4 offset:28672
    v_mfma_f32_16x16x32_bf16 v[104:107], v[16:19], v[200:203], v[104:107]
    ds_read_b64_tr_b16 v[14:15], v4 offset:30720
    v_mfma_f32_16x16x32_bf16 v[108:111], v[16:19], v[204:207], v[108:111]
    s_waitcnt lgkmcnt(0)
    s_barrier
    v_add_u32 v4, 0xffff0000, v4
    v_mfma_f32_16x16x32_bf16 v[100:103], v[20:23], v[208:211], v[100:103]
    ds_read_b64_tr_b16 v[16:17], v4 offset:0
    v_mfma_f32_16x16x32_bf16 v[104:107], v[20:23], v[212:215], v[104:107]
    ds_read_b64_tr_b16 v[18:19], v4 offset:2048
    v_mfma_f32_16x16x32_bf16 v[108:111], v[20:23], v[216:219], v[108:111]
    v_mfma_f32_16x16x32_bf16 v[100:103], v[24:27], v[220:223], v[100:103]
    ds_read_b64_tr_b16 v[20:21], v4 offset:4096
    v_mfma_f32_16x16x32_bf16 v[104:107], v[24:27], v[224:227], v[104:107]
    ds_read_b64_tr_b16 v[22:23], v4 offset:6144
    v_mfma_f32_16x16x32_bf16 v[108:111], v[24:27], v[228:231], v[108:111]
    v_mfma_f32_16x16x32_bf16 v[100:103], v[8:11], v[232:235], v[100:103]
    ds_read_b64_tr_b16 v[24:25], v4 offset:8192
    v_mfma_f32_16x16x32_bf16 v[104:107], v[8:11], v[236:239], v[104:107]
    ds_read_b64_tr_b16 v[26:27], v4 offset:10240
    v_mfma_f32_16x16x32_bf16 v[108:111], v[8:11], v[240:243], v[108:111]
    v_mfma_f32_16x16x32_bf16 v[100:103], v[12:15], v[244:247], v[100:103]
    ds_read_b64_tr_b16 v[8:9], v4 offset:12288
    v_mfma_f32_16x16x32_bf16 v[104:107], v[12:15], v[248:251], v[104:107]
    ds_read_b64_tr_b16 v[10:11], v4 offset:14336
    v_mfma_f32_16x16x32_bf16 v[108:111], v[12:15], v[252:255], v[108:111]
    s_waitcnt lgkmcnt(6)
    v_mfma_f32_16x16x32_bf16 v[124:127], v[16:19], v[160:163], 0
    ds_read_b64_tr_b16 v[12:13], v4 offset:16384
    v_mfma_f32_16x16x32_bf16 v[128:131], v[16:19], v[164:167], 0
    ds_read_b64_tr_b16 v[14:15], v4 offset:18432
    v_mfma_f32_16x16x32_bf16 v[132:135], v[16:19], v[168:171], 0
    s_waitcnt lgkmcnt(6)
    v_mfma_f32_16x16x32_bf16 v[124:127], v[20:23], v[172:175], v[124:127]
    ds_read_b64_tr_b16 v[16:17], v4 offset:20480
    v_mfma_f32_16x16x32_bf16 v[128:131], v[20:23], v[176:179], v[128:131]
    ds_read_b64_tr_b16 v[18:19], v4 offset:22528
    v_mfma_f32_16x16x32_bf16 v[132:135], v[20:23], v[180:183], v[132:135]
    s_waitcnt lgkmcnt(6)
    v_mfma_f32_16x16x32_bf16 v[124:127], v[24:27], v[184:187], v[124:127]
    ds_read_b64_tr_b16 v[20:21], v4 offset:24576
    v_mfma_f32_16x16x32_bf16 v[128:131], v[24:27], v[188:191], v[128:131]
    ds_read_b64_tr_b16 v[22:23], v4 offset:26624
    v_mfma_f32_16x16x32_bf16 v[132:135], v[24:27], v[192:195], v[132:135]
    s_waitcnt lgkmcnt(6)
    v_mfma_f32_16x16x32_bf16 v[124:127], v[8:11], v[196:199], v[124:127]
    ds_read_b64_tr_b16 v[24:25], v4 offset:28672
    v_mfma_f32_16x16x32_bf16 v[128:131], v[8:11], v[200:203], v[128:131]
    ds_read_b64_tr_b16 v[26:27], v4 offset:30720
    v_mfma_f32_16x16x32_bf16 v[132:135], v[8:11], v[204:207], v[132:135]
    s_waitcnt lgkmcnt(0)
    s_barrier
    v_add_u32 v4, 0x8000, v4
    v_mfma_f32_16x16x32_bf16 v[124:127], v[12:15], v[208:211], v[124:127]
    ds_read_b64_tr_b16 v[8:9], v4 offset:0
    v_mfma_f32_16x16x32_bf16 v[128:131], v[12:15], v[212:215], v[128:131]
    ds_read_b64_tr_b16 v[10:11], v4 offset:2048
    v_mfma_f32_16x16x32_bf16 v[132:135], v[12:15], v[216:219], v[132:135]
    v_mfma_f32_16x16x32_bf16 v[124:127], v[16:19], v[220:223], v[124:127]
    ds_read_b64_tr_b16 v[12:13], v4 offset:4096
    v_mfma_f32_16x16x32_bf16 v[128:131], v[16:19], v[224:227], v[128:131]
    ds_read_b64_tr_b16 v[14:15], v4 offset:6144
    v_mfma_f32_16x16x32_bf16 v[132:135], v[16:19], v[228:231], v[132:135]
    v_mfma_f32_16x16x32_bf16 v[124:127], v[20:23], v[232:235], v[124:127]
    ds_read_b64_tr_b16 v[16:17], v4 offset:8192
    v_mfma_f32_16x16x32_bf16 v[128:131], v[20:23], v[236:239], v[128:131]
    ds_read_b64_tr_b16 v[18:19], v4 offset:10240
    v_mfma_f32_16x16x32_bf16 v[132:135], v[20:23], v[240:243], v[132:135]
    v_mfma_f32_16x16x32_bf16 v[124:127], v[24:27], v[244:247], v[124:127]
    ds_read_b64_tr_b16 v[20:21], v4 offset:12288
    v_mfma_f32_16x16x32_bf16 v[128:131], v[24:27], v[248:251], v[128:131]
    ds_read_b64_tr_b16 v[22:23], v4 offset:14336
    v_mfma_f32_16x16x32_bf16 v[132:135], v[24:27], v[252:255], v[132:135]
    s_waitcnt lgkmcnt(6)
    v_mfma_f32_16x16x32_bf16 v[136:139], v[8:11], v[160:163], 0
    ds_read_b64_tr_b16 v[24:25], v4 offset:16384
    v_mfma_f32_16x16x32_bf16 v[140:143], v[8:11], v[164:167], 0
    ds_read_b64_tr_b16 v[26:27], v4 offset:18432
    v_mfma_f32_16x16x32_bf16 v[144:147], v[8:11], v[168:171], 0
    s_waitcnt lgkmcnt(6)
    v_mfma_f32_16x16x32_bf16 v[136:139], v[12:15], v[172:175], v[136:139]
    ds_read_b64_tr_b16 v[8:9], v4 offset:20480
    v_mfma_f32_16x16x32_bf16 v[140:143], v[12:15], v[176:179], v[140:143]
    ds_read_b64_tr_b16 v[10:11], v4 offset:22528
    v_mfma_f32_16x16x32_bf16 v[144:147], v[12:15], v[180:183], v[144:147]
    s_waitcnt lgkmcnt(6)
    v_mfma_f32_16x16x32_bf16 v[136:139], v[16:19], v[184:187], v[136:139]
    ds_read_b64_tr_b16 v[12:13], v4 offset:24576
    v_mfma_f32_16x16x32_bf16 v[140:143], v[16:19], v[188:191], v[140:143]
    ds_read_b64_tr_b16 v[14:15], v4 offset:26624
    v_mfma_f32_16x16x32_bf16 v[144:147], v[16:19], v[192:195], v[144:147]
    s_waitcnt lgkmcnt(6)
    v_mfma_f32_16x16x32_bf16 v[136:139], v[20:23], v[196:199], v[136:139]
    ds_read_b64_tr_b16 v[16:17], v4 offset:28672
    v_mfma_f32_16x16x32_bf16 v[140:143], v[20:23], v[200:203], v[140:143]
    ds_read_b64_tr_b16 v[18:19], v4 offset:30720
    v_mfma_f32_16x16x32_bf16 v[144:147], v[20:23], v[204:207], v[144:147]
    s_waitcnt lgkmcnt(0)
    s_barrier
    v_add_u32 v4, 0x8000, v4
    v_mfma_f32_16x16x32_bf16 v[136:139], v[24:27], v[208:211], v[136:139]
    ds_read_b64_tr_b16 v[20:21], v4 offset:0
    v_mfma_f32_16x16x32_bf16 v[140:143], v[24:27], v[212:215], v[140:143]
    ds_read_b64_tr_b16 v[22:23], v4 offset:2048
    v_mfma_f32_16x16x32_bf16 v[144:147], v[24:27], v[216:219], v[144:147]
    v_mfma_f32_16x16x32_bf16 v[136:139], v[8:11], v[220:223], v[136:139]
    ds_read_b64_tr_b16 v[24:25], v4 offset:4096
    v_mfma_f32_16x16x32_bf16 v[140:143], v[8:11], v[224:227], v[140:143]
    ds_read_b64_tr_b16 v[26:27], v4 offset:6144
    v_mfma_f32_16x16x32_bf16 v[144:147], v[8:11], v[228:231], v[144:147]
    v_mfma_f32_16x16x32_bf16 v[136:139], v[12:15], v[232:235], v[136:139]
    ds_read_b64_tr_b16 v[8:9], v4 offset:8192
    v_mfma_f32_16x16x32_bf16 v[140:143], v[12:15], v[236:239], v[140:143]
    ds_read_b64_tr_b16 v[10:11], v4 offset:10240
    v_mfma_f32_16x16x32_bf16 v[144:147], v[12:15], v[240:243], v[144:147]
    v_mfma_f32_16x16x32_bf16 v[136:139], v[16:19], v[244:247], v[136:139]
    ds_read_b64_tr_b16 v[12:13], v4 offset:12288
    v_mfma_f32_16x16x32_bf16 v[140:143], v[16:19], v[248:251], v[140:143]
    ds_read_b64_tr_b16 v[14:15], v4 offset:14336
    v_mfma_f32_16x16x32_bf16 v[144:147], v[16:19], v[252:255], v[144:147]
    s_waitcnt lgkmcnt(6)
    v_mfma_f32_16x16x32_bf16 v[148:151], v[20:23], v[160:163], 0
    ds_read_b64_tr_b16 v[16:17], v4 offset:16384
    v_mfma_f32_16x16x32_bf16 v[152:155], v[20:23], v[164:167], 0
    ds_read_b64_tr_b16 v[18:19], v4 offset:18432
    v_mfma_f32_16x16x32_bf16 v[156:159], v[20:23], v[168:171], 0
    s_waitcnt lgkmcnt(6)
    v_mfma_f32_16x16x32_bf16 v[148:151], v[24:27], v[172:175], v[148:151]
    ds_read_b64_tr_b16 v[20:21], v4 offset:20480
    v_mfma_f32_16x16x32_bf16 v[152:155], v[24:27], v[176:179], v[152:155]
    ds_read_b64_tr_b16 v[22:23], v4 offset:22528
    v_mfma_f32_16x16x32_bf16 v[156:159], v[24:27], v[180:183], v[156:159]
    s_waitcnt lgkmcnt(6)
    v_mfma_f32_16x16x32_bf16 v[148:151], v[8:11], v[184:187], v[148:151]
    ds_read_b64_tr_b16 v[24:25], v4 offset:24576
    v_mfma_f32_16x16x32_bf16 v[152:155], v[8:11], v[188:191], v[152:155]
    ds_read_b64_tr_b16 v[26:27], v4 offset:26624
    v_mfma_f32_16x16x32_bf16 v[156:159], v[8:11], v[192:195], v[156:159]
    s_waitcnt lgkmcnt(6)
    v_mfma_f32_16x16x32_bf16 v[148:151], v[12:15], v[196:199], v[148:151]
    ds_read_b64_tr_b16 v[8:9], v4 offset:28672
    v_mfma_f32_16x16x32_bf16 v[152:155], v[12:15], v[200:203], v[152:155]
    ds_read_b64_tr_b16 v[10:11], v4 offset:30720
    v_mfma_f32_16x16x32_bf16 v[156:159], v[12:15], v[204:207], v[156:159]
    s_waitcnt lgkmcnt(0)
    s_barrier
    v_add_u32 v4, 0xffff0000, v4
    v_mfma_f32_16x16x32_bf16 v[148:151], v[16:19], v[208:211], v[148:151]
    ds_read_b64_tr_b16 v[12:13], v4 offset:0
    v_mfma_f32_16x16x32_bf16 v[152:155], v[16:19], v[212:215], v[152:155]
    ds_read_b64_tr_b16 v[14:15], v4 offset:2048
    v_mfma_f32_16x16x32_bf16 v[156:159], v[16:19], v[216:219], v[156:159]
    v_mfma_f32_16x16x32_bf16 v[148:151], v[20:23], v[220:223], v[148:151]
    ds_read_b64_tr_b16 v[16:17], v4 offset:4096
    v_mfma_f32_16x16x32_bf16 v[152:155], v[20:23], v[224:227], v[152:155]
    ds_read_b64_tr_b16 v[18:19], v4 offset:6144
    v_mfma_f32_16x16x32_bf16 v[156:159], v[20:23], v[228:231], v[156:159]
    v_mfma_f32_16x16x32_bf16 v[148:151], v[24:27], v[232:235], v[148:151]
    ds_read_b64_tr_b16 v[20:21], v4 offset:8192
    v_mfma_f32_16x16x32_bf16 v[152:155], v[24:27], v[236:239], v[152:155]
    ds_read_b64_tr_b16 v[22:23], v4 offset:10240
    v_mfma_f32_16x16x32_bf16 v[156:159], v[24:27], v[240:243], v[156:159]
    v_mfma_f32_16x16x32_bf16 v[148:151], v[8:11], v[244:247], v[148:151]
    ds_read_b64_tr_b16 v[24:25], v4 offset:12288
    v_mfma_f32_16x16x32_bf16 v[152:155], v[8:11], v[248:251], v[152:155]
    ds_read_b64_tr_b16 v[26:27], v4 offset:14336
    v_mfma_f32_16x16x32_bf16 v[156:159], v[8:11], v[252:255], v[156:159]
    s_waitcnt lgkmcnt(6)
    v_mfma_f32_16x16x32_bf16 v[40:43], v[12:15], v[160:163], 0
    ds_read_b64_tr_b16 v[8:9], v4 offset:16384
    v_mfma_f32_16x16x32_bf16 v[44:47], v[12:15], v[164:167], 0
    ds_read_b64_tr_b16 v[10:11], v4 offset:18432
    v_mfma_f32_16x16x32_bf16 v[48:51], v[12:15], v[168:171], 0
    s_waitcnt lgkmcnt(6)
    v_mfma_f32_16x16x32_bf16 v[40:43], v[16:19], v[172:175], v[40:43]
    ds_read_b64_tr_b16 v[12:13], v4 offset:20480
    ds_read_b64_tr_b16 v[14:15], v4 offset:22528
    v_mfma_f32_16x16x32_bf16 v[44:47], v[16:19], v[176:179], v[44:47]
    ds_read_b128 v[160:163], v2 offset:32768
    ds_read_b128 v[164:167], v2 offset:36864
    v_mfma_f32_16x16x32_bf16 v[48:51], v[16:19], v[180:183], v[48:51]
    ds_read_b128 v[168:171], v2 offset:40960
    s_waitcnt lgkmcnt(9)
    v_mfma_f32_16x16x32_bf16 v[40:43], v[20:23], v[184:187], v[40:43]
    ds_read_b64_tr_b16 v[16:17], v4 offset:24576
    ds_read_b64_tr_b16 v[18:19], v4 offset:26624
    v_mfma_f32_16x16x32_bf16 v[44:47], v[20:23], v[188:191], v[44:47]
    ds_read_b128 v[172:175], v2 offset:33792
    ds_read_b128 v[176:179], v2 offset:37888
    v_mfma_f32_16x16x32_bf16 v[48:51], v[20:23], v[192:195], v[48:51]
    ds_read_b128 v[180:183], v2 offset:41984
    s_waitcnt lgkmcnt(12)
    v_mfma_f32_16x16x32_bf16 v[40:43], v[24:27], v[196:199], v[40:43]
    ds_read_b64_tr_b16 v[20:21], v4 offset:28672
    ds_read_b64_tr_b16 v[22:23], v4 offset:30720
    v_mfma_f32_16x16x32_bf16 v[44:47], v[24:27], v[200:203], v[44:47]
    ds_read_b128 v[184:187], v2 offset:34816
    ds_read_b128 v[188:191], v2 offset:38912
    v_mfma_f32_16x16x32_bf16 v[48:51], v[24:27], v[204:207], v[48:51]
    ds_read_b128 v[192:195], v2 offset:43008
    s_waitcnt lgkmcnt(3)
    s_barrier
    v_add_u32 v4, 0x8000, v4
    v_mfma_f32_16x16x32_bf16 v[40:43], v[8:11], v[208:211], v[40:43]
    ds_read_b64_tr_b16 v[24:25], v4 offset:0
    ds_read_b64_tr_b16 v[26:27], v4 offset:2048
    v_mfma_f32_16x16x32_bf16 v[44:47], v[8:11], v[212:215], v[44:47]
    ds_read_b128 v[196:199], v2 offset:35840
    ds_read_b128 v[200:203], v2 offset:39936
    v_mfma_f32_16x16x32_bf16 v[48:51], v[8:11], v[216:219], v[48:51]
    ds_read_b128 v[204:207], v2 offset:44032
    v_mfma_f32_16x16x32_bf16 v[40:43], v[12:15], v[220:223], v[40:43]
    ds_read_b64_tr_b16 v[8:9], v4 offset:4096
    ds_read_b64_tr_b16 v[10:11], v4 offset:6144
    v_mfma_f32_16x16x32_bf16 v[44:47], v[12:15], v[224:227], v[44:47]
    ds_read_b128 v[208:211], v2 offset:45056
    ds_read_b128 v[212:215], v2 offset:49152
    v_mfma_f32_16x16x32_bf16 v[48:51], v[12:15], v[228:231], v[48:51]
    ds_read_b128 v[216:219], v2 offset:53248
    v_mfma_f32_16x16x32_bf16 v[40:43], v[16:19], v[232:235], v[40:43]
    ds_read_b64_tr_b16 v[12:13], v4 offset:8192
    ds_read_b64_tr_b16 v[14:15], v4 offset:10240
    v_mfma_f32_16x16x32_bf16 v[44:47], v[16:19], v[236:239], v[44:47]
    ds_read_b128 v[220:223], v2 offset:46080
    ds_read_b128 v[224:227], v2 offset:50176
    v_mfma_f32_16x16x32_bf16 v[48:51], v[16:19], v[240:243], v[48:51]
    ds_read_b128 v[228:231], v2 offset:54272
    v_mfma_f32_16x16x32_bf16 v[40:43], v[20:23], v[244:247], v[40:43]
    ds_read_b64_tr_b16 v[16:17], v4 offset:12288
    ds_read_b64_tr_b16 v[18:19], v4 offset:14336
    v_mfma_f32_16x16x32_bf16 v[44:47], v[20:23], v[248:251], v[44:47]
    ds_read_b128 v[232:235], v2 offset:47104
    ds_read_b128 v[236:239], v2 offset:51200
    v_mfma_f32_16x16x32_bf16 v[48:51], v[20:23], v[252:255], v[48:51]
    ds_read_b128 v[240:243], v2 offset:55296
    s_waitcnt lgkmcnt(15)
    v_mfma_f32_16x16x32_bf16 v[28:31], v[24:27], v[160:163], v[28:31]
    ds_read_b64_tr_b16 v[20:21], v4 offset:16384
    ds_read_b64_tr_b16 v[22:23], v4 offset:18432
    v_mfma_f32_16x16x32_bf16 v[32:35], v[24:27], v[164:167], v[32:35]
    ds_read_b128 v[244:247], v2 offset:48128
    ds_read_b128 v[248:251], v2 offset:52224
    v_mfma_f32_16x16x32_bf16 v[36:39], v[24:27], v[168:171], v[36:39]
    ds_read_b128 v[252:255], v2 offset:56320
    s_waitcnt lgkmcnt(15)
    v_mfma_f32_16x16x32_bf16 v[28:31], v[8:11], v[172:175], v[28:31]
    ds_read_b64_tr_b16 v[24:25], v4 offset:20480
    v_mfma_f32_16x16x32_bf16 v[32:35], v[8:11], v[176:179], v[32:35]
    ds_read_b64_tr_b16 v[26:27], v4 offset:22528
    v_mfma_f32_16x16x32_bf16 v[36:39], v[8:11], v[180:183], v[36:39]
    s_waitcnt lgkmcnt(15)
    v_mfma_f32_16x16x32_bf16 v[28:31], v[12:15], v[184:187], v[28:31]
    ds_read_b64_tr_b16 v[8:9], v4 offset:24576
    v_mfma_f32_16x16x32_bf16 v[32:35], v[12:15], v[188:191], v[32:35]
    ds_read_b64_tr_b16 v[10:11], v4 offset:26624
    v_mfma_f32_16x16x32_bf16 v[36:39], v[12:15], v[192:195], v[36:39]
    s_waitcnt lgkmcnt(12)
    v_mfma_f32_16x16x32_bf16 v[28:31], v[16:19], v[196:199], v[28:31]
    ds_read_b64_tr_b16 v[12:13], v4 offset:28672
    v_mfma_f32_16x16x32_bf16 v[32:35], v[16:19], v[200:203], v[32:35]
    ds_read_b64_tr_b16 v[14:15], v4 offset:30720
    v_mfma_f32_16x16x32_bf16 v[36:39], v[16:19], v[204:207], v[36:39]
    s_waitcnt lgkmcnt(0)
    s_barrier
    v_add_u32 v4, 0x8000, v4
    v_mfma_f32_16x16x32_bf16 v[28:31], v[20:23], v[208:211], v[28:31]
    ds_read_b64_tr_b16 v[16:17], v4 offset:0
    v_mfma_f32_16x16x32_bf16 v[32:35], v[20:23], v[212:215], v[32:35]
    ds_read_b64_tr_b16 v[18:19], v4 offset:2048
    v_mfma_f32_16x16x32_bf16 v[36:39], v[20:23], v[216:219], v[36:39]
    v_mfma_f32_16x16x32_bf16 v[28:31], v[24:27], v[220:223], v[28:31]
    ds_read_b64_tr_b16 v[20:21], v4 offset:4096
    v_mfma_f32_16x16x32_bf16 v[32:35], v[24:27], v[224:227], v[32:35]
    ds_read_b64_tr_b16 v[22:23], v4 offset:6144
    v_mfma_f32_16x16x32_bf16 v[36:39], v[24:27], v[228:231], v[36:39]
    v_mfma_f32_16x16x32_bf16 v[28:31], v[8:11], v[232:235], v[28:31]
    ds_read_b64_tr_b16 v[24:25], v4 offset:8192
    v_mfma_f32_16x16x32_bf16 v[32:35], v[8:11], v[236:239], v[32:35]
    ds_read_b64_tr_b16 v[26:27], v4 offset:10240
    v_mfma_f32_16x16x32_bf16 v[36:39], v[8:11], v[240:243], v[36:39]
    v_mfma_f32_16x16x32_bf16 v[28:31], v[12:15], v[244:247], v[28:31]
    ds_read_b64_tr_b16 v[8:9], v4 offset:12288
    v_mfma_f32_16x16x32_bf16 v[32:35], v[12:15], v[248:251], v[32:35]
    ds_read_b64_tr_b16 v[10:11], v4 offset:14336
    v_mfma_f32_16x16x32_bf16 v[36:39], v[12:15], v[252:255], v[36:39]
    s_waitcnt lgkmcnt(6)
    v_mfma_f32_16x16x32_bf16 v[52:55], v[16:19], v[160:163], v[52:55]
    ds_read_b64_tr_b16 v[12:13], v4 offset:16384
    v_mfma_f32_16x16x32_bf16 v[56:59], v[16:19], v[164:167], v[56:59]
    ds_read_b64_tr_b16 v[14:15], v4 offset:18432
    v_mfma_f32_16x16x32_bf16 v[60:63], v[16:19], v[168:171], v[60:63]
    s_waitcnt lgkmcnt(6)
    v_mfma_f32_16x16x32_bf16 v[52:55], v[20:23], v[172:175], v[52:55]
    ds_read_b64_tr_b16 v[16:17], v4 offset:20480
    v_cvt_pk_bf16_f32 v28, v28, v29
    v_mfma_f32_16x16x32_bf16 v[56:59], v[20:23], v[176:179], v[56:59]
    ds_read_b64_tr_b16 v[18:19], v4 offset:22528
    v_cvt_pk_bf16_f32 v29, v30, v31
    v_mfma_f32_16x16x32_bf16 v[60:63], v[20:23], v[180:183], v[60:63]
    v_cvt_pk_bf16_f32 v30, v32, v33
    s_waitcnt lgkmcnt(6)
    v_mfma_f32_16x16x32_bf16 v[52:55], v[24:27], v[184:187], v[52:55]
    ds_read_b64_tr_b16 v[20:21], v4 offset:24576
    v_cvt_pk_bf16_f32 v31, v34, v35
    v_mfma_f32_16x16x32_bf16 v[56:59], v[24:27], v[188:191], v[56:59]
    ds_read_b64_tr_b16 v[22:23], v4 offset:26624
    v_cvt_pk_bf16_f32 v32, v36, v37
    v_mfma_f32_16x16x32_bf16 v[60:63], v[24:27], v[192:195], v[60:63]
    v_cvt_pk_bf16_f32 v33, v38, v39
    s_waitcnt lgkmcnt(6)
    v_mfma_f32_16x16x32_bf16 v[52:55], v[8:11], v[196:199], v[52:55]
    ds_read_b64_tr_b16 v[24:25], v4 offset:28672
    s_mov_b32 s26, 0
    buffer_store_dwordx4 v[28:31], v5, s[4:7], s26 offen sc0 sc1
    v_mfma_f32_16x16x32_bf16 v[56:59], v[8:11], v[200:203], v[56:59]
    ds_read_b64_tr_b16 v[26:27], v4 offset:30720
    buffer_store_dwordx2 v[32:33], v1, s[4:7], s26 offen offset:1024 sc0 sc1
    v_mfma_f32_16x16x32_bf16 v[60:63], v[8:11], v[204:207], v[60:63]
    s_waitcnt lgkmcnt(0)
    s_barrier
    v_add_u32 v4, 0xffff0000, v4
    v_mfma_f32_16x16x32_bf16 v[52:55], v[12:15], v[208:211], v[52:55]
    ds_read_b64_tr_b16 v[8:9], v4 offset:0
    v_mfma_f32_16x16x32_bf16 v[56:59], v[12:15], v[212:215], v[56:59]
    ds_read_b64_tr_b16 v[10:11], v4 offset:2048
    v_mfma_f32_16x16x32_bf16 v[60:63], v[12:15], v[216:219], v[60:63]
    v_mfma_f32_16x16x32_bf16 v[52:55], v[16:19], v[220:223], v[52:55]
    ds_read_b64_tr_b16 v[12:13], v4 offset:4096
    v_mfma_f32_16x16x32_bf16 v[56:59], v[16:19], v[224:227], v[56:59]
    ds_read_b64_tr_b16 v[14:15], v4 offset:6144
    v_mfma_f32_16x16x32_bf16 v[60:63], v[16:19], v[228:231], v[60:63]
    v_mfma_f32_16x16x32_bf16 v[52:55], v[20:23], v[232:235], v[52:55]
    ds_read_b64_tr_b16 v[16:17], v4 offset:8192
    v_mfma_f32_16x16x32_bf16 v[56:59], v[20:23], v[236:239], v[56:59]
    ds_read_b64_tr_b16 v[18:19], v4 offset:10240
    v_mfma_f32_16x16x32_bf16 v[60:63], v[20:23], v[240:243], v[60:63]
    v_mfma_f32_16x16x32_bf16 v[52:55], v[24:27], v[244:247], v[52:55]
    ds_read_b64_tr_b16 v[20:21], v4 offset:12288
    v_mfma_f32_16x16x32_bf16 v[56:59], v[24:27], v[248:251], v[56:59]
    ds_read_b64_tr_b16 v[22:23], v4 offset:14336
    v_mfma_f32_16x16x32_bf16 v[60:63], v[24:27], v[252:255], v[60:63]
    s_waitcnt lgkmcnt(6)
    v_mfma_f32_16x16x32_bf16 v[76:79], v[8:11], v[160:163], v[76:79]
    ds_read_b64_tr_b16 v[24:25], v4 offset:16384
    v_mfma_f32_16x16x32_bf16 v[80:83], v[8:11], v[164:167], v[80:83]
    ds_read_b64_tr_b16 v[26:27], v4 offset:18432
    v_mfma_f32_16x16x32_bf16 v[84:87], v[8:11], v[168:171], v[84:87]
    s_waitcnt lgkmcnt(6)
    v_mfma_f32_16x16x32_bf16 v[76:79], v[12:15], v[172:175], v[76:79]
    ds_read_b64_tr_b16 v[8:9], v4 offset:20480
    v_cvt_pk_bf16_f32 v52, v52, v53
    v_mfma_f32_16x16x32_bf16 v[80:83], v[12:15], v[176:179], v[80:83]
    ds_read_b64_tr_b16 v[10:11], v4 offset:22528
    v_cvt_pk_bf16_f32 v53, v54, v55
    v_mfma_f32_16x16x32_bf16 v[84:87], v[12:15], v[180:183], v[84:87]
    v_cvt_pk_bf16_f32 v54, v56, v57
    s_waitcnt lgkmcnt(6)
    v_mfma_f32_16x16x32_bf16 v[76:79], v[16:19], v[184:187], v[76:79]
    ds_read_b64_tr_b16 v[12:13], v4 offset:24576
    v_cvt_pk_bf16_f32 v55, v58, v59
    v_mfma_f32_16x16x32_bf16 v[80:83], v[16:19], v[188:191], v[80:83]
    ds_read_b64_tr_b16 v[14:15], v4 offset:26624
    v_cvt_pk_bf16_f32 v56, v60, v61
    v_mfma_f32_16x16x32_bf16 v[84:87], v[16:19], v[192:195], v[84:87]
    v_cvt_pk_bf16_f32 v57, v62, v63
    s_waitcnt lgkmcnt(6)
    v_mfma_f32_16x16x32_bf16 v[76:79], v[20:23], v[196:199], v[76:79]
    ds_read_b64_tr_b16 v[16:17], v4 offset:28672
    s_mov_b32 s26, 6144
    buffer_store_dwordx4 v[52:55], v5, s[4:7], s26 offen sc0 sc1
    v_mfma_f32_16x16x32_bf16 v[80:83], v[20:23], v[200:203], v[80:83]
    ds_read_b64_tr_b16 v[18:19], v4 offset:30720
    buffer_store_dwordx2 v[56:57], v1, s[4:7], s26 offen offset:1024 sc0 sc1
    v_mfma_f32_16x16x32_bf16 v[84:87], v[20:23], v[204:207], v[84:87]
    s_waitcnt lgkmcnt(0)
    s_barrier
    v_add_u32 v4, 0x8000, v4
    v_mfma_f32_16x16x32_bf16 v[76:79], v[24:27], v[208:211], v[76:79]
    ds_read_b64_tr_b16 v[20:21], v4 offset:0
    v_mfma_f32_16x16x32_bf16 v[80:83], v[24:27], v[212:215], v[80:83]
    ds_read_b64_tr_b16 v[22:23], v4 offset:2048
    v_mfma_f32_16x16x32_bf16 v[84:87], v[24:27], v[216:219], v[84:87]
    v_mfma_f32_16x16x32_bf16 v[76:79], v[8:11], v[220:223], v[76:79]
    ds_read_b64_tr_b16 v[24:25], v4 offset:4096
    v_mfma_f32_16x16x32_bf16 v[80:83], v[8:11], v[224:227], v[80:83]
    ds_read_b64_tr_b16 v[26:27], v4 offset:6144
    v_mfma_f32_16x16x32_bf16 v[84:87], v[8:11], v[228:231], v[84:87]
    v_mfma_f32_16x16x32_bf16 v[76:79], v[12:15], v[232:235], v[76:79]
    ds_read_b64_tr_b16 v[8:9], v4 offset:8192
    v_mfma_f32_16x16x32_bf16 v[80:83], v[12:15], v[236:239], v[80:83]
    ds_read_b64_tr_b16 v[10:11], v4 offset:10240
    v_mfma_f32_16x16x32_bf16 v[84:87], v[12:15], v[240:243], v[84:87]
    v_mfma_f32_16x16x32_bf16 v[76:79], v[16:19], v[244:247], v[76:79]
    ds_read_b64_tr_b16 v[12:13], v4 offset:12288
    v_mfma_f32_16x16x32_bf16 v[80:83], v[16:19], v[248:251], v[80:83]
    ds_read_b64_tr_b16 v[14:15], v4 offset:14336
    v_mfma_f32_16x16x32_bf16 v[84:87], v[16:19], v[252:255], v[84:87]
    s_waitcnt lgkmcnt(6)
    v_mfma_f32_16x16x32_bf16 v[100:103], v[20:23], v[160:163], v[100:103]
    ds_read_b64_tr_b16 v[16:17], v4 offset:16384
    v_mfma_f32_16x16x32_bf16 v[104:107], v[20:23], v[164:167], v[104:107]
    ds_read_b64_tr_b16 v[18:19], v4 offset:18432
    v_mfma_f32_16x16x32_bf16 v[108:111], v[20:23], v[168:171], v[108:111]
    s_waitcnt lgkmcnt(6)
    v_mfma_f32_16x16x32_bf16 v[100:103], v[24:27], v[172:175], v[100:103]
    ds_read_b64_tr_b16 v[20:21], v4 offset:20480
    v_cvt_pk_bf16_f32 v76, v76, v77
    v_mfma_f32_16x16x32_bf16 v[104:107], v[24:27], v[176:179], v[104:107]
    ds_read_b64_tr_b16 v[22:23], v4 offset:22528
    v_cvt_pk_bf16_f32 v77, v78, v79
    v_mfma_f32_16x16x32_bf16 v[108:111], v[24:27], v[180:183], v[108:111]
    v_cvt_pk_bf16_f32 v78, v80, v81
    s_waitcnt lgkmcnt(6)
    v_mfma_f32_16x16x32_bf16 v[100:103], v[8:11], v[184:187], v[100:103]
    ds_read_b64_tr_b16 v[24:25], v4 offset:24576
    v_cvt_pk_bf16_f32 v79, v82, v83
    v_mfma_f32_16x16x32_bf16 v[104:107], v[8:11], v[188:191], v[104:107]
    ds_read_b64_tr_b16 v[26:27], v4 offset:26624
    v_cvt_pk_bf16_f32 v80, v84, v85
    v_mfma_f32_16x16x32_bf16 v[108:111], v[8:11], v[192:195], v[108:111]
    v_cvt_pk_bf16_f32 v81, v86, v87
    s_waitcnt lgkmcnt(6)
    v_mfma_f32_16x16x32_bf16 v[100:103], v[12:15], v[196:199], v[100:103]
    ds_read_b64_tr_b16 v[8:9], v4 offset:28672
    s_mov_b32 s26, 12288
    buffer_store_dwordx4 v[76:79], v5, s[4:7], s26 offen sc0 sc1
    v_mfma_f32_16x16x32_bf16 v[104:107], v[12:15], v[200:203], v[104:107]
    ds_read_b64_tr_b16 v[10:11], v4 offset:30720
    buffer_store_dwordx2 v[80:81], v1, s[4:7], s26 offen offset:1024 sc0 sc1
    v_mfma_f32_16x16x32_bf16 v[108:111], v[12:15], v[204:207], v[108:111]
    s_waitcnt lgkmcnt(0)
    s_barrier
    v_add_u32 v4, 0x8000, v4
    v_mfma_f32_16x16x32_bf16 v[100:103], v[16:19], v[208:211], v[100:103]
    ds_read_b64_tr_b16 v[12:13], v4 offset:0
    v_mfma_f32_16x16x32_bf16 v[104:107], v[16:19], v[212:215], v[104:107]
    ds_read_b64_tr_b16 v[14:15], v4 offset:2048
    v_mfma_f32_16x16x32_bf16 v[108:111], v[16:19], v[216:219], v[108:111]
    v_mfma_f32_16x16x32_bf16 v[100:103], v[20:23], v[220:223], v[100:103]
    ds_read_b64_tr_b16 v[16:17], v4 offset:4096
    v_mfma_f32_16x16x32_bf16 v[104:107], v[20:23], v[224:227], v[104:107]
    ds_read_b64_tr_b16 v[18:19], v4 offset:6144
    v_mfma_f32_16x16x32_bf16 v[108:111], v[20:23], v[228:231], v[108:111]
    v_mfma_f32_16x16x32_bf16 v[100:103], v[24:27], v[232:235], v[100:103]
    ds_read_b64_tr_b16 v[20:21], v4 offset:8192
    v_mfma_f32_16x16x32_bf16 v[104:107], v[24:27], v[236:239], v[104:107]
    ds_read_b64_tr_b16 v[22:23], v4 offset:10240
    v_mfma_f32_16x16x32_bf16 v[108:111], v[24:27], v[240:243], v[108:111]
    v_mfma_f32_16x16x32_bf16 v[100:103], v[8:11], v[244:247], v[100:103]
    ds_read_b64_tr_b16 v[24:25], v4 offset:12288
    v_mfma_f32_16x16x32_bf16 v[104:107], v[8:11], v[248:251], v[104:107]
    ds_read_b64_tr_b16 v[26:27], v4 offset:14336
    v_mfma_f32_16x16x32_bf16 v[108:111], v[8:11], v[252:255], v[108:111]
    s_waitcnt lgkmcnt(6)
    v_mfma_f32_16x16x32_bf16 v[124:127], v[12:15], v[160:163], v[124:127]
    ds_read_b64_tr_b16 v[8:9], v4 offset:16384
    v_mfma_f32_16x16x32_bf16 v[128:131], v[12:15], v[164:167], v[128:131]
    ds_read_b64_tr_b16 v[10:11], v4 offset:18432
    v_mfma_f32_16x16x32_bf16 v[132:135], v[12:15], v[168:171], v[132:135]
    s_waitcnt lgkmcnt(6)
    v_mfma_f32_16x16x32_bf16 v[124:127], v[16:19], v[172:175], v[124:127]
    ds_read_b64_tr_b16 v[12:13], v4 offset:20480
    v_cvt_pk_bf16_f32 v100, v100, v101
    v_mfma_f32_16x16x32_bf16 v[128:131], v[16:19], v[176:179], v[128:131]
    ds_read_b64_tr_b16 v[14:15], v4 offset:22528
    v_cvt_pk_bf16_f32 v101, v102, v103
    v_mfma_f32_16x16x32_bf16 v[132:135], v[16:19], v[180:183], v[132:135]
    v_cvt_pk_bf16_f32 v102, v104, v105
    s_waitcnt lgkmcnt(6)
    v_mfma_f32_16x16x32_bf16 v[124:127], v[20:23], v[184:187], v[124:127]
    ds_read_b64_tr_b16 v[16:17], v4 offset:24576
    v_cvt_pk_bf16_f32 v103, v106, v107
    v_mfma_f32_16x16x32_bf16 v[128:131], v[20:23], v[188:191], v[128:131]
    ds_read_b64_tr_b16 v[18:19], v4 offset:26624
    v_cvt_pk_bf16_f32 v104, v108, v109
    v_mfma_f32_16x16x32_bf16 v[132:135], v[20:23], v[192:195], v[132:135]
    v_cvt_pk_bf16_f32 v105, v110, v111
    s_waitcnt lgkmcnt(6)
    v_mfma_f32_16x16x32_bf16 v[124:127], v[24:27], v[196:199], v[124:127]
    ds_read_b64_tr_b16 v[20:21], v4 offset:28672
    s_mov_b32 s26, 18432
    buffer_store_dwordx4 v[100:103], v5, s[4:7], s26 offen sc0 sc1
    v_mfma_f32_16x16x32_bf16 v[128:131], v[24:27], v[200:203], v[128:131]
    ds_read_b64_tr_b16 v[22:23], v4 offset:30720
    buffer_store_dwordx2 v[104:105], v1, s[4:7], s26 offen offset:1024 sc0 sc1
    v_mfma_f32_16x16x32_bf16 v[132:135], v[24:27], v[204:207], v[132:135]
    s_waitcnt lgkmcnt(0)
    s_barrier
    v_add_u32 v4, 0xffff0000, v4
    v_mfma_f32_16x16x32_bf16 v[124:127], v[8:11], v[208:211], v[124:127]
    ds_read_b64_tr_b16 v[24:25], v4 offset:0
    v_mfma_f32_16x16x32_bf16 v[128:131], v[8:11], v[212:215], v[128:131]
    ds_read_b64_tr_b16 v[26:27], v4 offset:2048
    v_mfma_f32_16x16x32_bf16 v[132:135], v[8:11], v[216:219], v[132:135]
    v_mfma_f32_16x16x32_bf16 v[124:127], v[12:15], v[220:223], v[124:127]
    ds_read_b64_tr_b16 v[8:9], v4 offset:4096
    v_mfma_f32_16x16x32_bf16 v[128:131], v[12:15], v[224:227], v[128:131]
    ds_read_b64_tr_b16 v[10:11], v4 offset:6144
    v_mfma_f32_16x16x32_bf16 v[132:135], v[12:15], v[228:231], v[132:135]
    v_mfma_f32_16x16x32_bf16 v[124:127], v[16:19], v[232:235], v[124:127]
    ds_read_b64_tr_b16 v[12:13], v4 offset:8192
    v_mfma_f32_16x16x32_bf16 v[128:131], v[16:19], v[236:239], v[128:131]
    ds_read_b64_tr_b16 v[14:15], v4 offset:10240
    v_mfma_f32_16x16x32_bf16 v[132:135], v[16:19], v[240:243], v[132:135]
    v_mfma_f32_16x16x32_bf16 v[124:127], v[20:23], v[244:247], v[124:127]
    ds_read_b64_tr_b16 v[16:17], v4 offset:12288
    v_mfma_f32_16x16x32_bf16 v[128:131], v[20:23], v[248:251], v[128:131]
    ds_read_b64_tr_b16 v[18:19], v4 offset:14336
    v_mfma_f32_16x16x32_bf16 v[132:135], v[20:23], v[252:255], v[132:135]
    s_waitcnt lgkmcnt(6)
    v_mfma_f32_16x16x32_bf16 v[136:139], v[24:27], v[160:163], v[136:139]
    ds_read_b64_tr_b16 v[20:21], v4 offset:16384
    v_mfma_f32_16x16x32_bf16 v[140:143], v[24:27], v[164:167], v[140:143]
    ds_read_b64_tr_b16 v[22:23], v4 offset:18432
    v_mfma_f32_16x16x32_bf16 v[144:147], v[24:27], v[168:171], v[144:147]
    s_waitcnt lgkmcnt(6)
    v_mfma_f32_16x16x32_bf16 v[136:139], v[8:11], v[172:175], v[136:139]
    ds_read_b64_tr_b16 v[24:25], v4 offset:20480
    v_cvt_pk_bf16_f32 v124, v124, v125
    v_mfma_f32_16x16x32_bf16 v[140:143], v[8:11], v[176:179], v[140:143]
    ds_read_b64_tr_b16 v[26:27], v4 offset:22528
    v_cvt_pk_bf16_f32 v125, v126, v127
    v_mfma_f32_16x16x32_bf16 v[144:147], v[8:11], v[180:183], v[144:147]
    v_cvt_pk_bf16_f32 v126, v128, v129
    s_waitcnt lgkmcnt(6)
    v_mfma_f32_16x16x32_bf16 v[136:139], v[12:15], v[184:187], v[136:139]
    ds_read_b64_tr_b16 v[8:9], v4 offset:24576
    v_cvt_pk_bf16_f32 v127, v130, v131
    v_mfma_f32_16x16x32_bf16 v[140:143], v[12:15], v[188:191], v[140:143]
    ds_read_b64_tr_b16 v[10:11], v4 offset:26624
    v_cvt_pk_bf16_f32 v128, v132, v133
    v_mfma_f32_16x16x32_bf16 v[144:147], v[12:15], v[192:195], v[144:147]
    v_cvt_pk_bf16_f32 v129, v134, v135
    s_waitcnt lgkmcnt(6)
    v_mfma_f32_16x16x32_bf16 v[136:139], v[16:19], v[196:199], v[136:139]
    ds_read_b64_tr_b16 v[12:13], v4 offset:28672
    s_mov_b32 s26, 24576
    buffer_store_dwordx4 v[124:127], v5, s[4:7], s26 offen sc0 sc1
    v_mfma_f32_16x16x32_bf16 v[140:143], v[16:19], v[200:203], v[140:143]
    ds_read_b64_tr_b16 v[14:15], v4 offset:30720
    buffer_store_dwordx2 v[128:129], v1, s[4:7], s26 offen offset:1024 sc0 sc1
    v_mfma_f32_16x16x32_bf16 v[144:147], v[16:19], v[204:207], v[144:147]
    s_waitcnt lgkmcnt(0)
    s_barrier
    v_add_u32 v4, 0x8000, v4
    v_mfma_f32_16x16x32_bf16 v[136:139], v[20:23], v[208:211], v[136:139]
    ds_read_b64_tr_b16 v[16:17], v4 offset:0
    v_mfma_f32_16x16x32_bf16 v[140:143], v[20:23], v[212:215], v[140:143]
    ds_read_b64_tr_b16 v[18:19], v4 offset:2048
    v_mfma_f32_16x16x32_bf16 v[144:147], v[20:23], v[216:219], v[144:147]
    v_mfma_f32_16x16x32_bf16 v[136:139], v[24:27], v[220:223], v[136:139]
    ds_read_b64_tr_b16 v[20:21], v4 offset:4096
    v_mfma_f32_16x16x32_bf16 v[140:143], v[24:27], v[224:227], v[140:143]
    ds_read_b64_tr_b16 v[22:23], v4 offset:6144
    v_mfma_f32_16x16x32_bf16 v[144:147], v[24:27], v[228:231], v[144:147]
    v_mfma_f32_16x16x32_bf16 v[136:139], v[8:11], v[232:235], v[136:139]
    ds_read_b64_tr_b16 v[24:25], v4 offset:8192
    v_mfma_f32_16x16x32_bf16 v[140:143], v[8:11], v[236:239], v[140:143]
    ds_read_b64_tr_b16 v[26:27], v4 offset:10240
    v_mfma_f32_16x16x32_bf16 v[144:147], v[8:11], v[240:243], v[144:147]
    v_mfma_f32_16x16x32_bf16 v[136:139], v[12:15], v[244:247], v[136:139]
    ds_read_b64_tr_b16 v[8:9], v4 offset:12288
    v_mfma_f32_16x16x32_bf16 v[140:143], v[12:15], v[248:251], v[140:143]
    ds_read_b64_tr_b16 v[10:11], v4 offset:14336
    v_mfma_f32_16x16x32_bf16 v[144:147], v[12:15], v[252:255], v[144:147]
    s_waitcnt lgkmcnt(6)
    v_mfma_f32_16x16x32_bf16 v[148:151], v[16:19], v[160:163], v[148:151]
    ds_read_b64_tr_b16 v[12:13], v4 offset:16384
    v_mfma_f32_16x16x32_bf16 v[152:155], v[16:19], v[164:167], v[152:155]
    ds_read_b64_tr_b16 v[14:15], v4 offset:18432
    v_mfma_f32_16x16x32_bf16 v[156:159], v[16:19], v[168:171], v[156:159]
    s_waitcnt lgkmcnt(6)
    v_mfma_f32_16x16x32_bf16 v[148:151], v[20:23], v[172:175], v[148:151]
    ds_read_b64_tr_b16 v[16:17], v4 offset:20480
    v_cvt_pk_bf16_f32 v136, v136, v137
    v_mfma_f32_16x16x32_bf16 v[152:155], v[20:23], v[176:179], v[152:155]
    ds_read_b64_tr_b16 v[18:19], v4 offset:22528
    v_cvt_pk_bf16_f32 v137, v138, v139
    v_mfma_f32_16x16x32_bf16 v[156:159], v[20:23], v[180:183], v[156:159]
    v_cvt_pk_bf16_f32 v138, v140, v141
    s_waitcnt lgkmcnt(6)
    v_mfma_f32_16x16x32_bf16 v[148:151], v[24:27], v[184:187], v[148:151]
    ds_read_b64_tr_b16 v[20:21], v4 offset:24576
    v_cvt_pk_bf16_f32 v139, v142, v143
    v_mfma_f32_16x16x32_bf16 v[152:155], v[24:27], v[188:191], v[152:155]
    ds_read_b64_tr_b16 v[22:23], v4 offset:26624
    v_cvt_pk_bf16_f32 v140, v144, v145
    v_mfma_f32_16x16x32_bf16 v[156:159], v[24:27], v[192:195], v[156:159]
    v_cvt_pk_bf16_f32 v141, v146, v147
    s_waitcnt lgkmcnt(6)
    v_mfma_f32_16x16x32_bf16 v[148:151], v[8:11], v[196:199], v[148:151]
    ds_read_b64_tr_b16 v[24:25], v4 offset:28672
    s_mov_b32 s26, 30720
    buffer_store_dwordx4 v[136:139], v5, s[4:7], s26 offen sc0 sc1
    v_mfma_f32_16x16x32_bf16 v[152:155], v[8:11], v[200:203], v[152:155]
    ds_read_b64_tr_b16 v[26:27], v4 offset:30720
    buffer_store_dwordx2 v[140:141], v1, s[4:7], s26 offen offset:1024 sc0 sc1
    v_mfma_f32_16x16x32_bf16 v[156:159], v[8:11], v[204:207], v[156:159]
    s_waitcnt lgkmcnt(0)
    s_waitcnt vmcnt(4)
    s_barrier
    v_add_u32 v4, 0x8000, v4
    v_mfma_f32_16x16x32_bf16 v[148:151], v[12:15], v[208:211], v[148:151]
    ds_read_b64_tr_b16 v[8:9], v4 offset:0
    v_mfma_f32_16x16x32_bf16 v[152:155], v[12:15], v[212:215], v[152:155]
    ds_read_b64_tr_b16 v[10:11], v4 offset:2048
    v_mfma_f32_16x16x32_bf16 v[156:159], v[12:15], v[216:219], v[156:159]
    v_mfma_f32_16x16x32_bf16 v[148:151], v[16:19], v[220:223], v[148:151]
    ds_read_b64_tr_b16 v[12:13], v4 offset:4096
    v_mfma_f32_16x16x32_bf16 v[152:155], v[16:19], v[224:227], v[152:155]
    ds_read_b64_tr_b16 v[14:15], v4 offset:6144
    v_mfma_f32_16x16x32_bf16 v[156:159], v[16:19], v[228:231], v[156:159]
    v_mfma_f32_16x16x32_bf16 v[148:151], v[20:23], v[232:235], v[148:151]
    ds_read_b64_tr_b16 v[16:17], v4 offset:8192
    v_mfma_f32_16x16x32_bf16 v[152:155], v[20:23], v[236:239], v[152:155]
    ds_read_b64_tr_b16 v[18:19], v4 offset:10240
    v_mfma_f32_16x16x32_bf16 v[156:159], v[20:23], v[240:243], v[156:159]
    v_mfma_f32_16x16x32_bf16 v[148:151], v[24:27], v[244:247], v[148:151]
    ds_read_b64_tr_b16 v[20:21], v4 offset:12288
    v_mfma_f32_16x16x32_bf16 v[152:155], v[24:27], v[248:251], v[152:155]
    ds_read_b64_tr_b16 v[22:23], v4 offset:14336
    v_mfma_f32_16x16x32_bf16 v[156:159], v[24:27], v[252:255], v[156:159]
    s_waitcnt lgkmcnt(6)
    v_mfma_f32_16x16x32_bf16 v[40:43], v[8:11], v[160:163], v[40:43]
    ds_read_b64_tr_b16 v[24:25], v4 offset:16384
    v_mfma_f32_16x16x32_bf16 v[44:47], v[8:11], v[164:167], v[44:47]
    ds_read_b64_tr_b16 v[26:27], v4 offset:18432
    v_mfma_f32_16x16x32_bf16 v[48:51], v[8:11], v[168:171], v[48:51]
    s_waitcnt lgkmcnt(6)
    v_mfma_f32_16x16x32_bf16 v[40:43], v[12:15], v[172:175], v[40:43]
    ds_read_b64_tr_b16 v[8:9], v4 offset:20480
    v_cvt_pk_bf16_f32 v148, v148, v149
    v_mfma_f32_16x16x32_bf16 v[44:47], v[12:15], v[176:179], v[44:47]
    ds_read_b64_tr_b16 v[10:11], v4 offset:22528
    v_cvt_pk_bf16_f32 v149, v150, v151
    v_mfma_f32_16x16x32_bf16 v[48:51], v[12:15], v[180:183], v[48:51]
    v_cvt_pk_bf16_f32 v150, v152, v153
    s_waitcnt lgkmcnt(6)
    v_mfma_f32_16x16x32_bf16 v[40:43], v[16:19], v[184:187], v[40:43]
    ds_read_b64_tr_b16 v[12:13], v4 offset:24576
    v_cvt_pk_bf16_f32 v151, v154, v155
    v_mfma_f32_16x16x32_bf16 v[44:47], v[16:19], v[188:191], v[44:47]
    ds_read_b64_tr_b16 v[14:15], v4 offset:26624
    v_cvt_pk_bf16_f32 v152, v156, v157
    v_mfma_f32_16x16x32_bf16 v[48:51], v[16:19], v[192:195], v[48:51]
    v_cvt_pk_bf16_f32 v153, v158, v159
    s_waitcnt lgkmcnt(6)
    v_mfma_f32_16x16x32_bf16 v[40:43], v[20:23], v[196:199], v[40:43]
    ds_read_b64_tr_b16 v[16:17], v4 offset:28672
    s_mov_b32 s26, 36864
    buffer_store_dwordx4 v[148:151], v5, s[4:7], s26 offen sc0 sc1
    v_mfma_f32_16x16x32_bf16 v[44:47], v[20:23], v[200:203], v[44:47]
    ds_read_b64_tr_b16 v[18:19], v4 offset:30720
    buffer_store_dwordx2 v[152:153], v1, s[4:7], s26 offen offset:1024 sc0 sc1
    v_mfma_f32_16x16x32_bf16 v[48:51], v[20:23], v[204:207], v[48:51]
    s_waitcnt lgkmcnt(0)
    s_barrier
    v_add_u32 v4, 0xffff0000, v4
    v_mfma_f32_16x16x32_bf16 v[40:43], v[24:27], v[208:211], v[40:43]
    ds_read_b64_tr_b16 v[20:21], v4 offset:0
    v_mfma_f32_16x16x32_bf16 v[44:47], v[24:27], v[212:215], v[44:47]
    ds_read_b64_tr_b16 v[22:23], v4 offset:2048
    v_mfma_f32_16x16x32_bf16 v[48:51], v[24:27], v[216:219], v[48:51]
    v_mfma_f32_16x16x32_bf16 v[40:43], v[8:11], v[220:223], v[40:43]
    ds_read_b64_tr_b16 v[24:25], v4 offset:4096
    v_mfma_f32_16x16x32_bf16 v[44:47], v[8:11], v[224:227], v[44:47]
    ds_read_b64_tr_b16 v[26:27], v4 offset:6144
    v_mfma_f32_16x16x32_bf16 v[48:51], v[8:11], v[228:231], v[48:51]
    v_mfma_f32_16x16x32_bf16 v[40:43], v[12:15], v[232:235], v[40:43]
    ds_read_b64_tr_b16 v[8:9], v4 offset:8192
    v_mfma_f32_16x16x32_bf16 v[44:47], v[12:15], v[236:239], v[44:47]
    ds_read_b64_tr_b16 v[10:11], v4 offset:10240
    v_mfma_f32_16x16x32_bf16 v[48:51], v[12:15], v[240:243], v[48:51]
    v_mfma_f32_16x16x32_bf16 v[40:43], v[16:19], v[244:247], v[40:43]
    ds_read_b64_tr_b16 v[12:13], v4 offset:12288
    v_mfma_f32_16x16x32_bf16 v[44:47], v[16:19], v[248:251], v[44:47]
    ds_read_b64_tr_b16 v[14:15], v4 offset:14336
    v_mfma_f32_16x16x32_bf16 v[48:51], v[16:19], v[252:255], v[48:51]
    s_waitcnt lgkmcnt(6)
    v_mfma_f32_16x16x32_bf16 v[64:67], v[20:23], v[160:163], 0
    ds_read_b64_tr_b16 v[16:17], v4 offset:16384
    v_mfma_f32_16x16x32_bf16 v[68:71], v[20:23], v[164:167], 0
    ds_read_b64_tr_b16 v[18:19], v4 offset:18432
    s_waitcnt vmcnt(2)
    s_mov_b64 exec, 0x30
    buffer_store_dword v7, v6, s[4:7], 0 offen sc0 sc1
    s_mov_b64 exec, -1
    v_mfma_f32_16x16x32_bf16 v[72:75], v[20:23], v[168:171], 0
    s_waitcnt lgkmcnt(6)
    v_mfma_f32_16x16x32_bf16 v[64:67], v[24:27], v[172:175], v[64:67]
    ds_read_b64_tr_b16 v[20:21], v4 offset:20480
    ds_read_b64_tr_b16 v[22:23], v4 offset:22528
    v_cvt_pk_bf16_f32 v40, v40, v41
    v_mfma_f32_16x16x32_bf16 v[68:71], v[24:27], v[176:179], v[68:71]
    ds_read_b128 v[160:163], v2 offset:0
    ds_read_b128 v[164:167], v2 offset:4096
    v_cvt_pk_bf16_f32 v41, v42, v43
    v_mfma_f32_16x16x32_bf16 v[72:75], v[24:27], v[180:183], v[72:75]
    ds_read_b128 v[168:171], v2 offset:8192
    v_cvt_pk_bf16_f32 v42, v44, v45
    s_waitcnt lgkmcnt(9)
    v_mfma_f32_16x16x32_bf16 v[64:67], v[8:11], v[184:187], v[64:67]
    ds_read_b64_tr_b16 v[24:25], v4 offset:24576
    ds_read_b64_tr_b16 v[26:27], v4 offset:26624
    v_cvt_pk_bf16_f32 v43, v46, v47
    v_mfma_f32_16x16x32_bf16 v[68:71], v[8:11], v[188:191], v[68:71]
    ds_read_b128 v[172:175], v2 offset:1024
    ds_read_b128 v[176:179], v2 offset:5120
    v_cvt_pk_bf16_f32 v44, v48, v49
    v_mfma_f32_16x16x32_bf16 v[72:75], v[8:11], v[192:195], v[72:75]
    ds_read_b128 v[180:183], v2 offset:9216
    v_cvt_pk_bf16_f32 v45, v50, v51
    s_waitcnt lgkmcnt(12)
    v_mfma_f32_16x16x32_bf16 v[64:67], v[12:15], v[196:199], v[64:67]
    ds_read_b64_tr_b16 v[8:9], v4 offset:28672
    ds_read_b64_tr_b16 v[10:11], v4 offset:30720
    s_mov_b32 s26, 43008
    buffer_store_dwordx4 v[40:43], v5, s[4:7], s26 offen sc0 sc1
    v_mfma_f32_16x16x32_bf16 v[68:71], v[12:15], v[200:203], v[68:71]
    ds_read_b128 v[184:187], v2 offset:2048
    ds_read_b128 v[188:191], v2 offset:6144
    buffer_store_dwordx2 v[44:45], v1, s[4:7], s26 offen offset:1024 sc0 sc1
    v_mfma_f32_16x16x32_bf16 v[72:75], v[12:15], v[204:207], v[72:75]
    ds_read_b128 v[192:195], v2 offset:10240
    s_waitcnt lgkmcnt(3)
    s_barrier
    v_add_u32 v4, 0x8000, v4
    v_mfma_f32_16x16x32_bf16 v[64:67], v[16:19], v[208:211], v[64:67]
    ds_read_b64_tr_b16 v[12:13], v4 offset:0
    ds_read_b64_tr_b16 v[14:15], v4 offset:2048
    v_mfma_f32_16x16x32_bf16 v[68:71], v[16:19], v[212:215], v[68:71]
    ds_read_b128 v[196:199], v2 offset:3072
    ds_read_b128 v[200:203], v2 offset:7168
    v_mfma_f32_16x16x32_bf16 v[72:75], v[16:19], v[216:219], v[72:75]
    ds_read_b128 v[204:207], v2 offset:11264
    v_mfma_f32_16x16x32_bf16 v[64:67], v[20:23], v[220:223], v[64:67]
    ds_read_b64_tr_b16 v[16:17], v4 offset:4096
    ds_read_b64_tr_b16 v[18:19], v4 offset:6144
    v_mfma_f32_16x16x32_bf16 v[68:71], v[20:23], v[224:227], v[68:71]
    ds_read_b128 v[208:211], v2 offset:12288
    ds_read_b128 v[212:215], v2 offset:16384
    v_mfma_f32_16x16x32_bf16 v[72:75], v[20:23], v[228:231], v[72:75]
    ds_read_b128 v[216:219], v2 offset:20480
    v_mfma_f32_16x16x32_bf16 v[64:67], v[24:27], v[232:235], v[64:67]
    ds_read_b64_tr_b16 v[20:21], v4 offset:8192
    ds_read_b64_tr_b16 v[22:23], v4 offset:10240
    v_mfma_f32_16x16x32_bf16 v[68:71], v[24:27], v[236:239], v[68:71]
    ds_read_b128 v[220:223], v2 offset:13312
    ds_read_b128 v[224:227], v2 offset:17408
    v_mfma_f32_16x16x32_bf16 v[72:75], v[24:27], v[240:243], v[72:75]
    ds_read_b128 v[228:231], v2 offset:21504
    v_mfma_f32_16x16x32_bf16 v[64:67], v[8:11], v[244:247], v[64:67]
    ds_read_b64_tr_b16 v[24:25], v4 offset:12288
    ds_read_b64_tr_b16 v[26:27], v4 offset:14336
    v_mfma_f32_16x16x32_bf16 v[68:71], v[8:11], v[248:251], v[68:71]
    ds_read_b128 v[232:235], v2 offset:14336
    ds_read_b128 v[236:239], v2 offset:18432
    v_mfma_f32_16x16x32_bf16 v[72:75], v[8:11], v[252:255], v[72:75]
    ds_read_b128 v[240:243], v2 offset:22528
    s_waitcnt lgkmcnt(15)
    v_mfma_f32_16x16x32_bf16 v[64:67], v[12:15], v[160:163], v[64:67]
    ds_read_b64_tr_b16 v[8:9], v4 offset:16384
    ds_read_b64_tr_b16 v[10:11], v4 offset:18432
    v_mfma_f32_16x16x32_bf16 v[68:71], v[12:15], v[164:167], v[68:71]
    ds_read_b128 v[244:247], v2 offset:15360
    ds_read_b128 v[248:251], v2 offset:19456
    v_mfma_f32_16x16x32_bf16 v[72:75], v[12:15], v[168:171], v[72:75]
    ds_read_b128 v[252:255], v2 offset:23552
    s_waitcnt lgkmcnt(15)
    v_mfma_f32_16x16x32_bf16 v[64:67], v[16:19], v[172:175], v[64:67]
    ds_read_b64_tr_b16 v[12:13], v4 offset:20480
    v_mfma_f32_16x16x32_bf16 v[68:71], v[16:19], v[176:179], v[68:71]
    ds_read_b64_tr_b16 v[14:15], v4 offset:22528
    v_mfma_f32_16x16x32_bf16 v[72:75], v[16:19], v[180:183], v[72:75]
    s_waitcnt lgkmcnt(15)
    v_mfma_f32_16x16x32_bf16 v[64:67], v[20:23], v[184:187], v[64:67]
    ds_read_b64_tr_b16 v[16:17], v4 offset:24576
    v_mfma_f32_16x16x32_bf16 v[68:71], v[20:23], v[188:191], v[68:71]
    ds_read_b64_tr_b16 v[18:19], v4 offset:26624
    v_mfma_f32_16x16x32_bf16 v[72:75], v[20:23], v[192:195], v[72:75]
    s_waitcnt lgkmcnt(12)
    v_mfma_f32_16x16x32_bf16 v[64:67], v[24:27], v[196:199], v[64:67]
    ds_read_b64_tr_b16 v[20:21], v4 offset:28672
    v_mfma_f32_16x16x32_bf16 v[68:71], v[24:27], v[200:203], v[68:71]
    ds_read_b64_tr_b16 v[22:23], v4 offset:30720
    v_mfma_f32_16x16x32_bf16 v[72:75], v[24:27], v[204:207], v[72:75]
    s_waitcnt lgkmcnt(9)
    v_mfma_f32_16x16x32_bf16 v[64:67], v[8:11], v[208:211], v[64:67]
    v_mfma_f32_16x16x32_bf16 v[68:71], v[8:11], v[212:215], v[68:71]
    v_mfma_f32_16x16x32_bf16 v[72:75], v[8:11], v[216:219], v[72:75]
    s_waitcnt lgkmcnt(4)
    v_mfma_f32_16x16x32_bf16 v[64:67], v[12:15], v[220:223], v[64:67]
    v_mfma_f32_16x16x32_bf16 v[68:71], v[12:15], v[224:227], v[68:71]
    v_mfma_f32_16x16x32_bf16 v[72:75], v[12:15], v[228:231], v[72:75]
    s_waitcnt lgkmcnt(2)
    v_mfma_f32_16x16x32_bf16 v[64:67], v[16:19], v[232:235], v[64:67]
    v_mfma_f32_16x16x32_bf16 v[68:71], v[16:19], v[236:239], v[68:71]
    v_mfma_f32_16x16x32_bf16 v[72:75], v[16:19], v[240:243], v[72:75]
    s_waitcnt lgkmcnt(0)
    v_mfma_f32_16x16x32_bf16 v[64:67], v[20:23], v[244:247], v[64:67]
    v_mfma_f32_16x16x32_bf16 v[68:71], v[20:23], v[248:251], v[68:71]
    v_mfma_f32_16x16x32_bf16 v[72:75], v[20:23], v[252:255], v[72:75]
    s_mul_i32 s50, s46, 3072
    s_add_u32 s50, s50, 32768
    v_add_u32 v4, s50, v2
    s_lshl_b32 s50, s46, 2
    s_add_u32 s50, s50, 24576
    v_mov_b32 v3, s50
    ds_write_b128 v4, v[64:67] offset:0
    ds_write_b128 v4, v[68:71] offset:1024
    ds_write_b128 v4, v[72:75] offset:2048
    ds_write_b32 v3, v7
    s_lshr_b32 s47, s43, 1
    s_lshl_b32 s48, s46, 1
    s_cmp_eq_u32 s47, s48
    s_cbranch_scc1 C_DUTY
    s_waitcnt vmcnt(0)
    s_mov_b64 exec, 0xc0
    buffer_store_dword v7, v6, s[4:7], 0 offen sc0 sc1
    s_mov_b64 exec, -1
    s_branch C_DONE
C_DUTY:
    s_add_u32 s57, s61, 4096
    s_load_dwordx8 s[32:39], s[40:41], s57 glc
    v_mov_b32 v8, v7
    v_and_b32 v1, 63, v0
    v_and_b32 v2, 15, v0
    v_lshrrev_b32 v3, 4, v1
    s_mov_b32 s47, 8
    s_add_u32 s48, s47, s44
    s_cmp_ge_u32 s48, 9
    s_cselect_b32 s58, 9, 0
    s_sub_u32 s48, s48, s58
    s_lshl_b32 s48, s48, 7
    s_mul_i32 s58, s62, 110592
    s_add_u32 s48, s48, s58
    s_mul_i32 s58, s42, 1152
    s_add_u32 s48, s48, s58
    s_lshl_b32 s58, s46, 5
    s_add_u32 s48, s48, s58
    v_mul_u32_u24 v7, 2304, v2
    v_lshl_add_u32 v7, v3, 3, v7
    v_add_u32 v7, s48, v7
    v_lshlrev_b32 v12, 4, v1
    v_mul_u32_u24 v13, 8, v1
    v_mov_b32 v14, 0x3f80
    v_mov_b32 v15, 0x3f800000
    s_lshl_b32 s51, s42, 4
    s_add_u32 s51, s51, s62
    s_mul_i32 s56, s51, 401408
    s_mul_i32 s58, s46, 1536
    s_add_u32 s56, s56, s58
    s_movk_i32 s49, 0x4800
    s_lshl_b32 s49, s49, 1
    s_lshl_b32 s50, s49, 1
    s_waitcnt vmcnt(0)
    s_mov_b64 exec, 0xc0
    buffer_store_dword v8, v6, s[4:7], 0 offen sc0 sc1
    s_mov_b64 exec, -1
    s_mov_b32 s59, 0
CS_P:
    s_waitcnt lgkmcnt(0)
    s_and_b64 s[16:17], s[32:33], s[34:35]
    s_and_b64 s[18:19], s[36:37], s[38:39]
    s_and_b64 s[16:17], s[16:17], s[18:19]
    s_and_b32 s16, s16, s17
    s_cbranch_scc1 CS_G
    s_load_dwordx8 s[32:39], s[40:41], s57 glc
    s_add_u32 s59, s59, 1
    s_cmp_lt_u32 s59, 0x40000
    s_cbranch_scc1 CS_P
    s_waitcnt lgkmcnt(0)
CS_G:
    buffer_load_dwordx4 v[32:35], v12, s[4:7], s56 offen sc0 sc1
    buffer_load_dwordx2 v[36:37], v13, s[4:7], s56 offen offset:1024 sc0 sc1
    s_add_u32 s56, s56, 50176
    buffer_load_dwordx4 v[38:41], v12, s[4:7], s56 offen sc0 sc1
    buffer_load_dwordx2 v[42:43], v13, s[4:7], s56 offen offset:1024 sc0 sc1
    s_add_u32 s56, s56, 50176
    buffer_load_dwordx4 v[44:47], v12, s[4:7], s56 offen sc0 sc1
    buffer_load_dwordx2 v[48:49], v13, s[4:7], s56 offen offset:1024 sc0 sc1
    s_add_u32 s56, s56, 50176
    buffer_load_dwordx4 v[50:53], v12, s[4:7], s56 offen sc0 sc1
    buffer_load_dwordx2 v[54:55], v13, s[4:7], s56 offen offset:1024 sc0 sc1
    s_add_u32 s56, s56, 50176
    buffer_load_dwordx4 v[56:59], v12, s[4:7], s56 offen sc0 sc1
    buffer_load_dwordx2 v[60:61], v13, s[4:7], s56 offen offset:1024 sc0 sc1
    s_add_u32 s56, s56, 50176
    buffer_load_dwordx4 v[62:65], v12, s[4:7], s56 offen sc0 sc1
    buffer_load_dwordx2 v[66:67], v13, s[4:7], s56 offen offset:1024 sc0 sc1
    s_add_u32 s56, s56, 50176
    buffer_load_dwordx4 v[68:71], v12, s[4:7], s56 offen sc0 sc1
    buffer_load_dwordx2 v[72:73], v13, s[4:7], s56 offen offset:1024 sc0 sc1
    s_add_u32 s56, s56, 50176
    buffer_load_dwordx4 v[74:77], v12, s[4:7], s56 offen sc0 sc1
    buffer_load_dwordx2 v[78:79], v13, s[4:7], s56 offen offset:1024 sc0 sc1
    s_waitcnt vmcnt(14)
    v_lshlrev_b32 v16, 16, v32
    v_and_b32 v17, 0xffff0000, v32
    v_lshlrev_b32 v18, 16, v33
    v_and_b32 v19, 0xffff0000, v33
    v_lshlrev_b32 v20, 16, v34
    v_and_b32 v21, 0xffff0000, v34
    v_lshlrev_b32 v22, 16, v35
    v_and_b32 v23, 0xffff0000, v35
    v_lshlrev_b32 v24, 16, v36
    v_and_b32 v25, 0xffff0000, v36
    v_lshlrev_b32 v26, 16, v37
    v_and_b32 v27, 0xffff0000, v37
    s_waitcnt vmcnt(12)
    v_dot2c_f32_bf16 v16, v38, v14
    v_dot2c_f32_bf16 v17, v38, v15
    v_dot2c_f32_bf16 v18, v39, v14
    v_dot2c_f32_bf16 v19, v39, v15
    v_dot2c_f32_bf16 v20, v40, v14
    v_dot2c_f32_bf16 v21, v40, v15
    v_dot2c_f32_bf16 v22, v41, v14
    v_dot2c_f32_bf16 v23, v41, v15
    v_dot2c_f32_bf16 v24, v42, v14
    v_dot2c_f32_bf16 v25, v42, v15
    v_dot2c_f32_bf16 v26, v43, v14
    v_dot2c_f32_bf16 v27, v43, v15
    s_waitcnt vmcnt(10)
    v_dot2c_f32_bf16 v16, v44, v14
    v_dot2c_f32_bf16 v17, v44, v15
    v_dot2c_f32_bf16 v18, v45, v14
    v_dot2c_f32_bf16 v19, v45, v15
    v_dot2c_f32_bf16 v20, v46, v14
    v_dot2c_f32_bf16 v21, v46, v15
    v_dot2c_f32_bf16 v22, v47, v14
    v_dot2c_f32_bf16 v23, v47, v15
    v_dot2c_f32_bf16 v24, v48, v14
    v_dot2c_f32_bf16 v25, v48, v15
    v_dot2c_f32_bf16 v26, v49, v14
    v_dot2c_f32_bf16 v27, v49, v15
    s_waitcnt vmcnt(8)
    v_dot2c_f32_bf16 v16, v50, v14
    v_dot2c_f32_bf16 v17, v50, v15
    v_dot2c_f32_bf16 v18, v51, v14
    v_dot2c_f32_bf16 v19, v51, v15
    v_dot2c_f32_bf16 v20, v52, v14
    v_dot2c_f32_bf16 v21, v52, v15
    v_dot2c_f32_bf16 v22, v53, v14
    v_dot2c_f32_bf16 v23, v53, v15
    v_dot2c_f32_bf16 v24, v54, v14
    v_dot2c_f32_bf16 v25, v54, v15
    v_dot2c_f32_bf16 v26, v55, v14
    v_dot2c_f32_bf16 v27, v55, v15
    s_waitcnt vmcnt(6)
    v_dot2c_f32_bf16 v16, v56, v14
    v_dot2c_f32_bf16 v17, v56, v15
    v_dot2c_f32_bf16 v18, v57, v14
    v_dot2c_f32_bf16 v19, v57, v15
    v_dot2c_f32_bf16 v20, v58, v14
    v_dot2c_f32_bf16 v21, v58, v15
    v_dot2c_f32_bf16 v22, v59, v14
    v_dot2c_f32_bf16 v23, v59, v15
    v_dot2c_f32_bf16 v24, v60, v14
    v_dot2c_f32_bf16 v25, v60, v15
    v_dot2c_f32_bf16 v26, v61, v14
    v_dot2c_f32_bf16 v27, v61, v15
    s_waitcnt vmcnt(4)
    v_dot2c_f32_bf16 v16, v62, v14
    v_dot2c_f32_bf16 v17, v62, v15
    v_dot2c_f32_bf16 v18, v63, v14
    v_dot2c_f32_bf16 v19, v63, v15
    v_dot2c_f32_bf16 v20, v64, v14
    v_dot2c_f32_bf16 v21, v64, v15
    v_dot2c_f32_bf16 v22, v65, v14
    v_dot2c_f32_bf16 v23, v65, v15
    v_dot2c_f32_bf16 v24, v66, v14
    v_dot2c_f32_bf16 v25, v66, v15
    v_dot2c_f32_bf16 v26, v67, v14
    v_dot2c_f32_bf16 v27, v67, v15
    s_waitcnt vmcnt(2)
    v_dot2c_f32_bf16 v16, v68, v14
    v_dot2c_f32_bf16 v17, v68, v15
    v_dot2c_f32_bf16 v18, v69, v14
    v_dot2c_f32_bf16 v19, v69, v15
    v_dot2c_f32_bf16 v20, v70, v14
    v_dot2c_f32_bf16 v21, v70, v15
    v_dot2c_f32_bf16 v22, v71, v14
    v_dot2c_f32_bf16 v23, v71, v15
    v_dot2c_f32_bf16 v24, v72, v14
    v_dot2c_f32_bf16 v25, v72, v15
    v_dot2c_f32_bf16 v26, v73, v14
    v_dot2c_f32_bf16 v27, v73, v15
    s_waitcnt vmcnt(0)
    v_dot2c_f32_bf16 v16, v74, v14
    v_dot2c_f32_bf16 v17, v74, v15
    v_dot2c_f32_bf16 v18, v75, v14
    v_dot2c_f32_bf16 v19, v75, v15
    v_dot2c_f32_bf16 v20, v76, v14
    v_dot2c_f32_bf16 v21, v76, v15
    v_dot2c_f32_bf16 v22, v77, v14
    v_dot2c_f32_bf16 v23, v77, v15
    v_dot2c_f32_bf16 v24, v78, v14
    v_dot2c_f32_bf16 v25, v78, v15
    v_dot2c_f32_bf16 v26, v79, v14
    v_dot2c_f32_bf16 v27, v79, v15
    s_nop 2
    v_cvt_pk_bf16_f32 v16, v16, v17
    v_cvt_pk_bf16_f32 v17, v18, v19
    v_cvt_pk_bf16_f32 v18, v20, v21
    v_cvt_pk_bf16_f32 v19, v22, v23
    v_cvt_pk_bf16_f32 v20, v24, v25
    v_cvt_pk_bf16_f32 v21, v26, v27
    buffer_store_dwordx2 v[16:17], v7, s[8:11], 0 offen
    buffer_store_dwordx2 v[18:19], v7, s[8:11], s49 offen
    buffer_store_dwordx2 v[20:21], v7, s[8:11], s50 offen
C_DONE:
    s_endpgm
CODE_END:
.section .rodata,"a"
.p2align 6
.amdhsa_kernel concat_heads__gqa_block_cached__mha_block_cached__near_ridge_kernel
  .amdhsa_next_free_vgpr 256
  .amdhsa_next_free_sgpr 102
  .amdhsa_accum_offset 256
  .amdhsa_group_segment_fixed_size 0
  .amdhsa_kernarg_size 104
  .amdhsa_user_sgpr_count 2
  .amdhsa_user_sgpr_kernarg_segment_ptr 1
  .amdhsa_system_sgpr_workgroup_id_x 1
.end_amdhsa_kernel
```
